```python
import torch

def _softmax(x, axis=-1):
    return torch.softmax(x, dim=axis)
def _gelu(x):
    return torch.nn.functional.gelu(x, approximate="tanh")
def _silu(x):
    return torch.nn.functional.silu(x)
def _sigmoid(x):
    return torch.sigmoid(x)
def _layernorm(x, axis=-1, eps=1e-5):
    m = x.mean(dim=axis, keepdim=True)
    v = x.var(dim=axis, keepdim=True, unbiased=False)
    return (x - m) / torch.sqrt(v + eps)
def _scatter_add(tgt, idx, src, axis=0):
    return tgt.clone().index_add_(axis, idx, src)
def _segment_sum(src, seg, n):
    out = torch.zeros((n,) + src.shape[1:], dtype=src.dtype)
    return out.index_add_(0, seg, src)
def _pad(x, pw):
    flat = tuple(v for pair in reversed(pw) for v in pair)
    return torch.nn.functional.pad(x, flat)

kernel_name = 'standalone__gqa_block_cached__near_ridge'

def setup_inputs():

    _w = (lambda a: (lambda t: t.to(torch.bfloat16) if t.is_floating_point() else t)(torch.as_tensor(a)))
    B, Sq, D = 16, 64, 576
    Hq, Hkv, Sk, Dh = 32, 16, 1024, 128
    assert Hq % Hkv == 0, (Hq, Hkv)
    return {
        "x": _w((lambda *s: torch.randn(*s, dtype=torch.bfloat16) * 0.8)(B, Sq, D)),
        "k_cache": _w((lambda *s: torch.randn(*s, dtype=torch.bfloat16) * 0.8)(B, Hkv, Sk, Dh)),
        "v_cache": _w((lambda *s: torch.randn(*s, dtype=torch.bfloat16) * 0.05)(B, Hkv, Sk, Dh)),
        "wq": _w((lambda *s: torch.randn(*s, dtype=torch.bfloat16) * 0.8)(D, Hq * Dh) * (D ** -0.5)),
        "wo": _w((lambda *s: torch.randn(*s, dtype=torch.bfloat16) * 0.05)(Hq * Dh, D) * ((Hq * Dh) ** -0.5)),
    }

def reference(x, k_cache, v_cache, wq, wo):
    B, Sq, D = x.shape
    Hq, Dh = 32, 128
    Hkv = k_cache.shape[1]
    rep = Hq // Hkv
    q = (lambda x, *d: x.permute(*d))((x @ wq).reshape(B, Sq, Hq, Dh), 0, 2, 1, 3)
    k = (lambda x, n, axis: torch.repeat_interleave(x, n, dim=axis))(k_cache, rep, axis=1)
    v = (lambda x, n, axis: torch.repeat_interleave(x, n, dim=axis))(v_cache, rep, axis=1)
    scores = torch.einsum("bhqd,bhkd->bhqk", q, k) * (Dh ** -0.5)
    p = _softmax(scores, axis=-1)
    o = torch.einsum("bhqk,bhkd->bhqd", p, v)
    return (lambda x, *d: x.permute(*d))(o, 0, 2, 1, 3).reshape(B, Sq, Hq * Dh) @ wo
```

```asm
; @launch kernel=attn_kernel grid=(256,1,1) block=(512,1,1) lds=163840
; @launch kernel=red_kernel grid=(288,1,1) block=(256,1,1) lds=0
.amdgcn_target "amdgcn-amd-amdhsa--gfx950"
.text
.globl attn_kernel
.p2align 8
.type attn_kernel,@function
attn_kernel:
    s_cmp_ge_u32 s2, 256
    s_cbranch_scc1 L_attn_done
    s_load_dwordx4 s[40:43], s[0:1], 0
    s_load_dwordx4 s[44:47], s[0:1], 16
    s_load_dwordx2 s[48:49], s[0:1], 32
    s_load_dwordx2 s[50:51], s[0:1], 56
    v_and_b32 v1, 63, v0
    v_lshrrev_b32 v18, 6, v0
    s_nop 0
    v_readfirstlane_b32 s28, v18
    s_nop 3
    s_lshr_b32 s29, s28, 2
    s_and_b32 s30, s28, 3
    s_lshl_b32 s31, s28, 10
    s_lshr_b32 s39, s30, 1
    s_waitcnt lgkmcnt(0)
    s_lshl_b32 s32, s2, 18
    s_lshr_b32 s33, s2, 14
    s_add_u32 s42, s42, s32
    s_addc_u32 s43, s43, s33
    s_add_u32 s44, s44, s32
    s_addc_u32 s45, s45, s33
    s_mov_b32 s4, s42
    s_and_b32 s5, s43, 0xffff
    s_mov_b32 s6, 262144
    s_mov_b32 s7, 0x00020000
    s_mov_b32 s8, s44
    s_and_b32 s9, s45, 0xffff
    s_mov_b32 s10, 262144
    s_mov_b32 s11, 0x00020000
    s_and_b32 s32, s2, 15
    s_lshl_b32 s33, s32, 9
    s_add_u32 s46, s46, s33
    s_addc_u32 s47, s47, 0
    s_mov_b32 s12, s46
    s_and_b32 s13, s47, 0xffff
    s_mov_b32 s14, 0
    s_mov_b32 s15, 0x00020000
    s_sub_u32 s14, 4718592, s33
    s_lshr_b32 s33, s2, 4
    s_mul_i32 s34, s33, 73728
    s_add_u32 s40, s40, s34
    s_addc_u32 s41, s41, 0
    s_mov_b32 s16, s40
    s_and_b32 s17, s41, 0xffff
    s_mov_b32 s18, 73728
    s_mov_b32 s19, 0x00020000
    s_mul_i32 s34, s32, 294912
    s_add_u32 s48, s48, s34
    s_addc_u32 s49, s49, 0
    s_mov_b32 s20, s48
    s_and_b32 s21, s49, 0xffff
    s_mov_b32 s22, 294912
    s_mov_b32 s23, 0x00020000
    s_mul_i32 s34, s2, 73728
    s_add_u32 s50, s50, s34
    s_addc_u32 s51, s51, 0
    s_mov_b32 s24, s50
    s_and_b32 s25, s51, 0xffff
    s_mov_b32 s26, 73728
    s_mov_b32 s27, 0x00020000
    s_and_b32 s40, s30, 1
    s_lshr_b32 s41, s2, 3
    s_and_b32 s41, s41, 15
    s_lshl_b32 s41, s41, 14
    s_mov_b32 s36, 0x3e0293ee
    v_lshrrev_b32 v245, 5, v1
    v_and_b32 v246, 31, v1
    v_lshlrev_b32 v243, 4, v1
    v_lshrrev_b32 v18, 3, v1
    s_lshl_b32 s32, s28, 3
    v_add_u32 v18, s32, v18
    v_bfe_u32 v19, v18, 1, 3
    s_movk_i32 s34, 1152
    v_mul_lo_u32 v18, v18, s34
    v_and_b32 v20, 7, v1
    v_xor_b32 v19, v19, v20
    v_lshl_add_u32 v251, v19, 4, v18
    s_lshl_b32 s32, s40, 5
    v_add_u32 v18, s32, v246
    v_bfe_u32 v19, v18, 1, 3
    v_lshlrev_b32 v18, 7, v18
    v_add_u32 v18, 32768, v18
    v_or_b32 v20, 0, v245
    v_xor_b32 v20, v20, v19
    v_lshl_add_u32 v247, v20, 4, v18
    v_or_b32 v20, 2, v245
    v_xor_b32 v20, v20, v19
    v_lshl_add_u32 v248, v20, 4, v18
    v_or_b32 v20, 4, v245
    v_xor_b32 v20, v20, v19
    v_lshl_add_u32 v249, v20, 4, v18
    v_or_b32 v20, 6, v245
    v_xor_b32 v20, v20, v19
    v_lshl_add_u32 v250, v20, 4, v18
    s_lshl_b32 s32, s28, 1
    v_add_u32 v19, s32, v245
    v_and_b32 v20, 3, v19
    v_lshlrev_b32 v20, 2, v20
    v_xor_b32 v20, v20, v246
    v_lshlrev_b32 v20, 4, v20
    v_lshl_add_u32 v232, v19, 13, v20
    v_lshrrev_b32 v18, 4, v1
    v_and_b32 v19, 15, v1
    s_lshl_b32 s32, s30, 2
    v_add_u32 v20, s32, v18
    v_xor_b32 v20, v20, v19
    v_lshlrev_b32 v20, 4, v20
    s_lshl_b32 s32, s28, 2
    v_add_u32 v21, s32, v18
    v_lshl_add_u32 v14, v21, 8, v20
    v_lshlrev_b32 v20, 2, v18
    v_xor_b32 v20, v20, v19
    v_lshlrev_b32 v20, 4, v20
    v_lshl_add_u32 v15, v21, 8, v20
    v_and_b32 v18, 15, v1
    v_or_b32 v19, 0, v245
    v_xor_b32 v19, v19, v18
    v_lshlrev_b32 v19, 4, v19
    v_lshl_add_u32 v2, v246, 8, v19
    v_or_b32 v19, 2, v245
    v_xor_b32 v19, v19, v18
    v_lshlrev_b32 v19, 4, v19
    v_lshl_add_u32 v3, v246, 8, v19
    v_or_b32 v19, 4, v245
    v_xor_b32 v19, v19, v18
    v_lshlrev_b32 v19, 4, v19
    v_lshl_add_u32 v4, v246, 8, v19
    v_or_b32 v19, 6, v245
    v_xor_b32 v19, v19, v18
    v_lshlrev_b32 v19, 4, v19
    v_lshl_add_u32 v5, v246, 8, v19
    v_or_b32 v19, 8, v245
    v_xor_b32 v19, v19, v18
    v_lshlrev_b32 v19, 4, v19
    v_lshl_add_u32 v6, v246, 8, v19
    v_or_b32 v19, 10, v245
    v_xor_b32 v19, v19, v18
    v_lshlrev_b32 v19, 4, v19
    v_lshl_add_u32 v7, v246, 8, v19
    v_or_b32 v19, 12, v245
    v_xor_b32 v19, v19, v18
    v_lshlrev_b32 v19, 4, v19
    v_lshl_add_u32 v8, v246, 8, v19
    v_or_b32 v19, 14, v245
    v_xor_b32 v19, v19, v18
    v_lshlrev_b32 v19, 4, v19
    v_lshl_add_u32 v9, v246, 8, v19
    v_bfe_u32 v18, v1, 4, 1
    v_bfe_u32 v19, v1, 2, 2
    v_and_b32 v20, 3, v1
    v_lshlrev_b32 v21, 5, v18
    v_lshl_add_u32 v21, v20, 3, v21
    v_lshl_add_u32 v22, v245, 2, v19
    v_lshl_add_u32 v22, v22, 8, v21
    v_xor_b32 v23, 0, v19
    v_lshl_add_u32 v10, v23, 6, v22
    v_xor_b32 v23, 1, v19
    v_lshl_add_u32 v11, v23, 6, v22
    v_xor_b32 v23, 2, v19
    v_lshl_add_u32 v12, v23, 6, v22
    v_xor_b32 v23, 3, v19
    v_lshl_add_u32 v13, v23, 6, v22
    v_lshl_add_u32 v22, v245, 3, v19
    v_lshl_add_u32 v22, v22, 9, v21
    s_lshl_b32 s32, s39, 2
    s_lshl_b32 s33, s29, 1
    s_add_u32 s32, s32, s33
    s_add_u32 s33, s32, 0
    v_xor_b32 v23, s33, v19
    v_lshl_add_u32 v233, v23, 6, v22
    s_add_u32 s33, s32, 1
    v_xor_b32 v23, s33, v19
    v_lshl_add_u32 v234, v23, 6, v22
    s_lshl_b32 s32, s39, 4
    v_lshl_add_u32 v22, v245, 2, v19
    v_add_u32 v22, s32, v22
    s_movk_i32 s33, 1152
    v_mul_lo_u32 v22, v22, s33
    s_mul_i32 s32, s29, 576
    v_add3_u32 v241, v22, s32, v21
    s_add_u32 s32, s31, 0
    v_add_u32 v18, s32, v243
    v_mov_b32 v19, 18432
    v_cmp_ge_u32 vcc, v18, v19
    v_mov_b32 v20, 129024
    s_nop 1
    v_cndmask_b32 v20, 0, v20, vcc
    v_add_u32 v236, v18, v20
    s_add_u32 s32, s31, 8192
    v_add_u32 v18, s32, v243
    v_mov_b32 v19, 18432
    v_cmp_ge_u32 vcc, v18, v19
    v_mov_b32 v20, 129024
    s_nop 1
    v_cndmask_b32 v20, 0, v20, vcc
    v_add_u32 v237, v18, v20
    s_add_u32 s32, s31, 16384
    v_add_u32 v18, s32, v243
    v_mov_b32 v19, 18432
    v_cmp_ge_u32 vcc, v18, v19
    v_mov_b32 v20, 129024
    s_nop 1
    v_cndmask_b32 v20, 0, v20, vcc
    v_add_u32 v238, v18, v20
    s_add_u32 s32, s31, 24576
    v_add_u32 v18, s32, v243
    v_mov_b32 v19, 18432
    v_cmp_ge_u32 vcc, v18, v19
    v_mov_b32 v20, 129024
    s_nop 1
    v_cndmask_b32 v20, 0, v20, vcc
    v_add_u32 v239, v18, v20
    s_and_b32 s32, s31, 0xfff
    s_add_u32 s32, s32, 32768
    v_add_u32 v18, s32, v243
    v_mov_b32 v19, 18432
    v_cmp_ge_u32 vcc, v18, v19
    v_mov_b32 v20, 129024
    s_nop 1
    v_cndmask_b32 v20, 0, v20, vcc
    v_add_u32 v240, v18, v20
    s_lshl_b32 s32, s30, 13
    s_add_u32 s32, s32, 98304
    v_lshlrev_b32 v242, 8, v246
    v_add_u32 v242, s32, v242
    v_lshl_add_u32 v242, v245, 3, v242
    s_add_u32 m0, s31, 0
    s_mov_b32 s35, 0
    buffer_load_dwordx4 v232, s[12:15], s35 offen lds
    s_add_u32 m0, s31, 8192
    s_mov_b32 s35, 131072
    buffer_load_dwordx4 v232, s[12:15], s35 offen lds
    s_add_u32 m0, s31, 16384
    s_mov_b32 s35, 262144
    buffer_load_dwordx4 v232, s[12:15], s35 offen lds
    s_add_u32 m0, s31, 24576
    s_mov_b32 s35, 393216
    buffer_load_dwordx4 v232, s[12:15], s35 offen lds
    s_add_u32 m0, s31, 32768
    s_mov_b32 s35, 0
    buffer_load_dwordx4 v251, s[16:19], s35 offen lds
    s_add_u32 m0, s31, 40960
    s_mov_b32 s35, 524288
    buffer_load_dwordx4 v232, s[12:15], s35 offen lds
    s_add_u32 m0, s31, 49152
    s_mov_b32 s35, 655360
    buffer_load_dwordx4 v232, s[12:15], s35 offen lds
    s_add_u32 m0, s31, 57344
    s_mov_b32 s35, 786432
    buffer_load_dwordx4 v232, s[12:15], s35 offen lds
    s_add_u32 m0, s31, 65536
    s_mov_b32 s35, 917504
    buffer_load_dwordx4 v232, s[12:15], s35 offen lds
    s_add_u32 m0, s31, 73728
    s_mov_b32 s35, 128
    buffer_load_dwordx4 v251, s[16:19], s35 offen lds
    s_add_u32 m0, s31, 131072
    s_add_u32 s35, s41, 0
    s_and_b32 s35, s35, 0x3ffff
    buffer_load_dwordx4 v14, s[4:7], s35 offen nt lds
    s_add_u32 m0, s31, 139264
    s_add_u32 s35, s41, 8192
    s_and_b32 s35, s35, 0x3ffff
    buffer_load_dwordx4 v14, s[4:7], s35 offen nt lds
    s_add_u32 m0, s31, 147456
    s_add_u32 s35, s41, 16384
    s_and_b32 s35, s35, 0x3ffff
    buffer_load_dwordx4 v14, s[4:7], s35 offen nt lds
    s_add_u32 m0, s31, 155648
    s_add_u32 s35, s41, 24576
    s_and_b32 s35, s35, 0x3ffff
    buffer_load_dwordx4 v14, s[4:7], s35 offen nt lds
    s_waitcnt vmcnt(9)
    s_barrier
    s_add_u32 m0, s31, 81920
    s_mov_b32 s35, 1048576
    buffer_load_dwordx4 v232, s[12:15], s35 offen lds
    s_add_u32 m0, s31, 90112
    s_mov_b32 s35, 1179648
    buffer_load_dwordx4 v232, s[12:15], s35 offen lds
    s_add_u32 m0, s31, 98304
    s_mov_b32 s35, 1310720
    buffer_load_dwordx4 v232, s[12:15], s35 offen lds
    s_add_u32 m0, s31, 106496
    s_mov_b32 s35, 1441792
    buffer_load_dwordx4 v232, s[12:15], s35 offen lds
    s_add_u32 m0, s31, 114688
    s_mov_b32 s35, 256
    buffer_load_dwordx4 v251, s[16:19], s35 offen lds
    v_add_u32 v18, 0, v233
    v_add_u32 v19, 0, v234
    v_add_u32 v20, 0, v247
    v_add_u32 v21, 0, v248
    v_add_u32 v22, 0, v249
    v_add_u32 v23, 0, v250
    ds_read_b128 v[168:171], v20
    ds_read_b128 v[172:175], v21
    ds_read_b128 v[176:179], v22
    ds_read_b128 v[180:183], v23
    ds_read_b64_tr_b16 v[200:201], v18 offset:0
    ds_read_b64_tr_b16 v[202:203], v18 offset:2048
    ds_read_b64_tr_b16 v[204:205], v19 offset:0
    ds_read_b64_tr_b16 v[206:207], v19 offset:2048
    ds_read_b64_tr_b16 v[208:209], v18 offset:8192
    ds_read_b64_tr_b16 v[210:211], v18 offset:10240
    ds_read_b64_tr_b16 v[212:213], v19 offset:8192
    ds_read_b64_tr_b16 v[214:215], v19 offset:10240
    ds_read_b64_tr_b16 v[216:217], v18 offset:16384
    ds_read_b64_tr_b16 v[218:219], v18 offset:18432
    s_waitcnt lgkmcnt(6)
    ds_read_b64_tr_b16 v[220:221], v19 offset:16384
    ds_read_b64_tr_b16 v[222:223], v19 offset:18432
    ds_read_b64_tr_b16 v[224:225], v18 offset:24576
    ds_read_b64_tr_b16 v[226:227], v18 offset:26624
    ds_read_b64_tr_b16 v[228:229], v19 offset:24576
    ds_read_b64_tr_b16 v[230:231], v19 offset:26624
    s_waitcnt lgkmcnt(14)
    v_mfma_f32_32x32x16_bf16 v[24:39], v[200:203], v[168:171], 0
    s_waitcnt lgkmcnt(12)
    v_mfma_f32_32x32x16_bf16 v[40:55], v[204:207], v[168:171], 0
    s_waitcnt lgkmcnt(10)
    v_mfma_f32_32x32x16_bf16 v[24:39], v[208:211], v[172:175], v[24:39]
    s_waitcnt lgkmcnt(8)
    v_mfma_f32_32x32x16_bf16 v[40:55], v[212:215], v[172:175], v[40:55]
    s_waitcnt lgkmcnt(6)
    v_mfma_f32_32x32x16_bf16 v[24:39], v[216:219], v[176:179], v[24:39]
    s_waitcnt lgkmcnt(4)
    v_mfma_f32_32x32x16_bf16 v[40:55], v[220:223], v[176:179], v[40:55]
    s_waitcnt lgkmcnt(2)
    v_mfma_f32_32x32x16_bf16 v[24:39], v[224:227], v[180:183], v[24:39]
    s_waitcnt lgkmcnt(0)
    v_mfma_f32_32x32x16_bf16 v[40:55], v[228:231], v[180:183], v[40:55]
    s_waitcnt vmcnt(9)
    s_barrier
    s_add_u32 m0, s31, 0
    s_mov_b32 s35, 1572864
    buffer_load_dwordx4 v232, s[12:15], s35 offen lds
    s_add_u32 m0, s31, 8192
    s_mov_b32 s35, 1703936
    buffer_load_dwordx4 v232, s[12:15], s35 offen lds
    s_add_u32 m0, s31, 16384
    s_mov_b32 s35, 1835008
    buffer_load_dwordx4 v232, s[12:15], s35 offen lds
    s_add_u32 m0, s31, 24576
    s_mov_b32 s35, 1966080
    buffer_load_dwordx4 v232, s[12:15], s35 offen lds
    s_add_u32 m0, s31, 32768
    s_mov_b32 s35, 384
    buffer_load_dwordx4 v251, s[16:19], s35 offen lds
    v_add_u32 v18, 40960, v233
    v_add_u32 v19, 40960, v234
    v_add_u32 v20, 40960, v247
    v_add_u32 v21, 40960, v248
    v_add_u32 v22, 40960, v249
    v_add_u32 v23, 40960, v250
    ds_read_b128 v[168:171], v20
    ds_read_b128 v[172:175], v21
    ds_read_b128 v[176:179], v22
    ds_read_b128 v[180:183], v23
    ds_read_b64_tr_b16 v[200:201], v18 offset:0
    ds_read_b64_tr_b16 v[202:203], v18 offset:2048
    ds_read_b64_tr_b16 v[204:205], v19 offset:0
    ds_read_b64_tr_b16 v[206:207], v19 offset:2048
    ds_read_b64_tr_b16 v[208:209], v18 offset:8192
    ds_read_b64_tr_b16 v[210:211], v18 offset:10240
    ds_read_b64_tr_b16 v[212:213], v19 offset:8192
    ds_read_b64_tr_b16 v[214:215], v19 offset:10240
    ds_read_b64_tr_b16 v[216:217], v18 offset:16384
    ds_read_b64_tr_b16 v[218:219], v18 offset:18432
    s_waitcnt lgkmcnt(6)
    ds_read_b64_tr_b16 v[220:221], v19 offset:16384
    ds_read_b64_tr_b16 v[222:223], v19 offset:18432
    ds_read_b64_tr_b16 v[224:225], v18 offset:24576
    ds_read_b64_tr_b16 v[226:227], v18 offset:26624
    ds_read_b64_tr_b16 v[228:229], v19 offset:24576
    ds_read_b64_tr_b16 v[230:231], v19 offset:26624
    s_waitcnt lgkmcnt(14)
    v_mfma_f32_32x32x16_bf16 v[24:39], v[200:203], v[168:171], v[24:39]
    s_waitcnt lgkmcnt(12)
    v_mfma_f32_32x32x16_bf16 v[40:55], v[204:207], v[168:171], v[40:55]
    s_waitcnt lgkmcnt(10)
    v_mfma_f32_32x32x16_bf16 v[24:39], v[208:211], v[172:175], v[24:39]
    s_waitcnt lgkmcnt(8)
    v_mfma_f32_32x32x16_bf16 v[40:55], v[212:215], v[172:175], v[40:55]
    s_waitcnt lgkmcnt(6)
    v_mfma_f32_32x32x16_bf16 v[24:39], v[216:219], v[176:179], v[24:39]
    s_waitcnt lgkmcnt(4)
    v_mfma_f32_32x32x16_bf16 v[40:55], v[220:223], v[176:179], v[40:55]
    s_waitcnt lgkmcnt(2)
    v_mfma_f32_32x32x16_bf16 v[24:39], v[224:227], v[180:183], v[24:39]
    s_waitcnt lgkmcnt(0)
    v_mfma_f32_32x32x16_bf16 v[40:55], v[228:231], v[180:183], v[40:55]
    s_waitcnt vmcnt(5)
    s_barrier
    s_add_u32 m0, s31, 40960
    s_mov_b32 s35, 2097152
    buffer_load_dwordx4 v232, s[12:15], s35 offen lds
    s_add_u32 m0, s31, 49152
    s_mov_b32 s35, 2228224
    buffer_load_dwordx4 v232, s[12:15], s35 offen lds
    s_add_u32 m0, s31, 57344
    s_mov_b32 s35, 2359296
    buffer_load_dwordx4 v232, s[12:15], s35 offen lds
    s_add_u32 m0, s31, 65536
    s_mov_b32 s35, 2490368
    buffer_load_dwordx4 v232, s[12:15], s35 offen lds
    s_add_u32 m0, s31, 73728
    s_mov_b32 s35, 512
    buffer_load_dwordx4 v251, s[16:19], s35 offen lds
    v_add_u32 v18, 81920, v233
    v_add_u32 v19, 81920, v234
    v_add_u32 v20, 81920, v247
    v_add_u32 v21, 81920, v248
    v_add_u32 v22, 81920, v249
    v_add_u32 v23, 81920, v250
    ds_read_b128 v[168:171], v20
    ds_read_b128 v[172:175], v21
    ds_read_b128 v[176:179], v22
    ds_read_b128 v[180:183], v23
    ds_read_b64_tr_b16 v[200:201], v18 offset:0
    ds_read_b64_tr_b16 v[202:203], v18 offset:2048
    ds_read_b64_tr_b16 v[204:205], v19 offset:0
    ds_read_b64_tr_b16 v[206:207], v19 offset:2048
    ds_read_b64_tr_b16 v[208:209], v18 offset:8192
    ds_read_b64_tr_b16 v[210:211], v18 offset:10240
    ds_read_b64_tr_b16 v[212:213], v19 offset:8192
    ds_read_b64_tr_b16 v[214:215], v19 offset:10240
    ds_read_b64_tr_b16 v[216:217], v18 offset:16384
    ds_read_b64_tr_b16 v[218:219], v18 offset:18432
    s_waitcnt lgkmcnt(6)
    ds_read_b64_tr_b16 v[220:221], v19 offset:16384
    ds_read_b64_tr_b16 v[222:223], v19 offset:18432
    ds_read_b64_tr_b16 v[224:225], v18 offset:24576
    ds_read_b64_tr_b16 v[226:227], v18 offset:26624
    ds_read_b64_tr_b16 v[228:229], v19 offset:24576
    ds_read_b64_tr_b16 v[230:231], v19 offset:26624
    s_waitcnt lgkmcnt(14)
    v_mfma_f32_32x32x16_bf16 v[24:39], v[200:203], v[168:171], v[24:39]
    s_waitcnt lgkmcnt(12)
    v_mfma_f32_32x32x16_bf16 v[40:55], v[204:207], v[168:171], v[40:55]
    s_waitcnt lgkmcnt(10)
    v_mfma_f32_32x32x16_bf16 v[24:39], v[208:211], v[172:175], v[24:39]
    s_waitcnt lgkmcnt(8)
    v_mfma_f32_32x32x16_bf16 v[40:55], v[212:215], v[172:175], v[40:55]
    s_waitcnt lgkmcnt(6)
    v_mfma_f32_32x32x16_bf16 v[24:39], v[216:219], v[176:179], v[24:39]
    s_waitcnt lgkmcnt(4)
    v_mfma_f32_32x32x16_bf16 v[40:55], v[220:223], v[176:179], v[40:55]
    s_waitcnt lgkmcnt(2)
    v_mfma_f32_32x32x16_bf16 v[24:39], v[224:227], v[180:183], v[24:39]
    s_waitcnt lgkmcnt(0)
    v_mfma_f32_32x32x16_bf16 v[40:55], v[228:231], v[180:183], v[40:55]
    s_waitcnt vmcnt(5)
    s_barrier
    s_add_u32 m0, s31, 81920
    s_mov_b32 s35, 2621440
    buffer_load_dwordx4 v232, s[12:15], s35 offen lds
    s_add_u32 m0, s31, 90112
    s_mov_b32 s35, 2752512
    buffer_load_dwordx4 v232, s[12:15], s35 offen lds
    s_add_u32 m0, s31, 98304
    s_mov_b32 s35, 2883584
    buffer_load_dwordx4 v232, s[12:15], s35 offen lds
    s_add_u32 m0, s31, 106496
    s_mov_b32 s35, 3014656
    buffer_load_dwordx4 v232, s[12:15], s35 offen lds
    s_add_u32 m0, s31, 114688
    s_mov_b32 s35, 640
    buffer_load_dwordx4 v251, s[16:19], s35 offen lds
    v_add_u32 v18, 0, v233
    v_add_u32 v19, 0, v234
    v_add_u32 v20, 0, v247
    v_add_u32 v21, 0, v248
    v_add_u32 v22, 0, v249
    v_add_u32 v23, 0, v250
    ds_read_b128 v[168:171], v20
    ds_read_b128 v[172:175], v21
    ds_read_b128 v[176:179], v22
    ds_read_b128 v[180:183], v23
    ds_read_b64_tr_b16 v[200:201], v18 offset:0
    ds_read_b64_tr_b16 v[202:203], v18 offset:2048
    ds_read_b64_tr_b16 v[204:205], v19 offset:0
    ds_read_b64_tr_b16 v[206:207], v19 offset:2048
    ds_read_b64_tr_b16 v[208:209], v18 offset:8192
    ds_read_b64_tr_b16 v[210:211], v18 offset:10240
    ds_read_b64_tr_b16 v[212:213], v19 offset:8192
    ds_read_b64_tr_b16 v[214:215], v19 offset:10240
    ds_read_b64_tr_b16 v[216:217], v18 offset:16384
    ds_read_b64_tr_b16 v[218:219], v18 offset:18432
    s_waitcnt lgkmcnt(6)
    ds_read_b64_tr_b16 v[220:221], v19 offset:16384
    ds_read_b64_tr_b16 v[222:223], v19 offset:18432
    ds_read_b64_tr_b16 v[224:225], v18 offset:24576
    ds_read_b64_tr_b16 v[226:227], v18 offset:26624
    ds_read_b64_tr_b16 v[228:229], v19 offset:24576
    ds_read_b64_tr_b16 v[230:231], v19 offset:26624
    s_waitcnt lgkmcnt(14)
    v_mfma_f32_32x32x16_bf16 v[24:39], v[200:203], v[168:171], v[24:39]
    s_waitcnt lgkmcnt(12)
    v_mfma_f32_32x32x16_bf16 v[40:55], v[204:207], v[168:171], v[40:55]
    s_waitcnt lgkmcnt(10)
    v_mfma_f32_32x32x16_bf16 v[24:39], v[208:211], v[172:175], v[24:39]
    s_waitcnt lgkmcnt(8)
    v_mfma_f32_32x32x16_bf16 v[40:55], v[212:215], v[172:175], v[40:55]
    s_waitcnt lgkmcnt(6)
    v_mfma_f32_32x32x16_bf16 v[24:39], v[216:219], v[176:179], v[24:39]
    s_waitcnt lgkmcnt(4)
    v_mfma_f32_32x32x16_bf16 v[40:55], v[220:223], v[176:179], v[40:55]
    s_waitcnt lgkmcnt(2)
    v_mfma_f32_32x32x16_bf16 v[24:39], v[224:227], v[180:183], v[24:39]
    s_waitcnt lgkmcnt(0)
    v_mfma_f32_32x32x16_bf16 v[40:55], v[228:231], v[180:183], v[40:55]
    s_waitcnt vmcnt(5)
    s_barrier
    s_add_u32 m0, s31, 0
    s_mov_b32 s35, 3145728
    buffer_load_dwordx4 v232, s[12:15], s35 offen lds
    s_add_u32 m0, s31, 8192
    s_mov_b32 s35, 3276800
    buffer_load_dwordx4 v232, s[12:15], s35 offen lds
    s_add_u32 m0, s31, 16384
    s_mov_b32 s35, 3407872
    buffer_load_dwordx4 v232, s[12:15], s35 offen lds
    s_add_u32 m0, s31, 24576
    s_mov_b32 s35, 3538944
    buffer_load_dwordx4 v232, s[12:15], s35 offen lds
    s_add_u32 m0, s31, 32768
    s_mov_b32 s35, 768
    buffer_load_dwordx4 v251, s[16:19], s35 offen lds
    v_add_u32 v18, 40960, v233
    v_add_u32 v19, 40960, v234
    v_add_u32 v20, 40960, v247
    v_add_u32 v21, 40960, v248
    v_add_u32 v22, 40960, v249
    v_add_u32 v23, 40960, v250
    ds_read_b128 v[168:171], v20
    ds_read_b128 v[172:175], v21
    ds_read_b128 v[176:179], v22
    ds_read_b128 v[180:183], v23
    ds_read_b64_tr_b16 v[200:201], v18 offset:0
    ds_read_b64_tr_b16 v[202:203], v18 offset:2048
    ds_read_b64_tr_b16 v[204:205], v19 offset:0
    ds_read_b64_tr_b16 v[206:207], v19 offset:2048
    ds_read_b64_tr_b16 v[208:209], v18 offset:8192
    ds_read_b64_tr_b16 v[210:211], v18 offset:10240
    ds_read_b64_tr_b16 v[212:213], v19 offset:8192
    ds_read_b64_tr_b16 v[214:215], v19 offset:10240
    ds_read_b64_tr_b16 v[216:217], v18 offset:16384
    ds_read_b64_tr_b16 v[218:219], v18 offset:18432
    s_waitcnt lgkmcnt(6)
    ds_read_b64_tr_b16 v[220:221], v19 offset:16384
    ds_read_b64_tr_b16 v[222:223], v19 offset:18432
    ds_read_b64_tr_b16 v[224:225], v18 offset:24576
    ds_read_b64_tr_b16 v[226:227], v18 offset:26624
    ds_read_b64_tr_b16 v[228:229], v19 offset:24576
    ds_read_b64_tr_b16 v[230:231], v19 offset:26624
    s_waitcnt lgkmcnt(14)
    v_mfma_f32_32x32x16_bf16 v[24:39], v[200:203], v[168:171], v[24:39]
    s_waitcnt lgkmcnt(12)
    v_mfma_f32_32x32x16_bf16 v[40:55], v[204:207], v[168:171], v[40:55]
    s_waitcnt lgkmcnt(10)
    v_mfma_f32_32x32x16_bf16 v[24:39], v[208:211], v[172:175], v[24:39]
    s_waitcnt lgkmcnt(8)
    v_mfma_f32_32x32x16_bf16 v[40:55], v[212:215], v[172:175], v[40:55]
    s_waitcnt lgkmcnt(6)
    v_mfma_f32_32x32x16_bf16 v[24:39], v[216:219], v[176:179], v[24:39]
    s_waitcnt lgkmcnt(4)
    v_mfma_f32_32x32x16_bf16 v[40:55], v[220:223], v[176:179], v[40:55]
    s_waitcnt lgkmcnt(2)
    v_mfma_f32_32x32x16_bf16 v[24:39], v[224:227], v[180:183], v[24:39]
    s_waitcnt lgkmcnt(0)
    v_mfma_f32_32x32x16_bf16 v[40:55], v[228:231], v[180:183], v[40:55]
    s_waitcnt vmcnt(5)
    s_barrier
    s_add_u32 m0, s31, 40960
    s_mov_b32 s35, 3670016
    buffer_load_dwordx4 v232, s[12:15], s35 offen lds
    s_add_u32 m0, s31, 49152
    s_mov_b32 s35, 3801088
    buffer_load_dwordx4 v232, s[12:15], s35 offen lds
    s_add_u32 m0, s31, 57344
    s_mov_b32 s35, 3932160
    buffer_load_dwordx4 v232, s[12:15], s35 offen lds
    s_add_u32 m0, s31, 65536
    s_mov_b32 s35, 4063232
    buffer_load_dwordx4 v232, s[12:15], s35 offen lds
    s_add_u32 m0, s31, 73728
    s_mov_b32 s35, 896
    buffer_load_dwordx4 v251, s[16:19], s35 offen lds
    v_add_u32 v18, 81920, v233
    v_add_u32 v19, 81920, v234
    v_add_u32 v20, 81920, v247
    v_add_u32 v21, 81920, v248
    v_add_u32 v22, 81920, v249
    v_add_u32 v23, 81920, v250
    ds_read_b128 v[168:171], v20
    ds_read_b128 v[172:175], v21
    ds_read_b128 v[176:179], v22
    ds_read_b128 v[180:183], v23
    ds_read_b64_tr_b16 v[200:201], v18 offset:0
    ds_read_b64_tr_b16 v[202:203], v18 offset:2048
    ds_read_b64_tr_b16 v[204:205], v19 offset:0
    ds_read_b64_tr_b16 v[206:207], v19 offset:2048
    ds_read_b64_tr_b16 v[208:209], v18 offset:8192
    ds_read_b64_tr_b16 v[210:211], v18 offset:10240
    ds_read_b64_tr_b16 v[212:213], v19 offset:8192
    ds_read_b64_tr_b16 v[214:215], v19 offset:10240
    ds_read_b64_tr_b16 v[216:217], v18 offset:16384
    ds_read_b64_tr_b16 v[218:219], v18 offset:18432
    s_waitcnt lgkmcnt(6)
    ds_read_b64_tr_b16 v[220:221], v19 offset:16384
    ds_read_b64_tr_b16 v[222:223], v19 offset:18432
    ds_read_b64_tr_b16 v[224:225], v18 offset:24576
    ds_read_b64_tr_b16 v[226:227], v18 offset:26624
    ds_read_b64_tr_b16 v[228:229], v19 offset:24576
    ds_read_b64_tr_b16 v[230:231], v19 offset:26624
    s_waitcnt lgkmcnt(14)
    v_mfma_f32_32x32x16_bf16 v[24:39], v[200:203], v[168:171], v[24:39]
    s_waitcnt lgkmcnt(12)
    v_mfma_f32_32x32x16_bf16 v[40:55], v[204:207], v[168:171], v[40:55]
    s_waitcnt lgkmcnt(10)
    v_mfma_f32_32x32x16_bf16 v[24:39], v[208:211], v[172:175], v[24:39]
    s_waitcnt lgkmcnt(8)
    v_mfma_f32_32x32x16_bf16 v[40:55], v[212:215], v[172:175], v[40:55]
    s_waitcnt lgkmcnt(6)
    v_mfma_f32_32x32x16_bf16 v[24:39], v[216:219], v[176:179], v[24:39]
    s_waitcnt lgkmcnt(4)
    v_mfma_f32_32x32x16_bf16 v[40:55], v[220:223], v[176:179], v[40:55]
    s_waitcnt lgkmcnt(2)
    v_mfma_f32_32x32x16_bf16 v[24:39], v[224:227], v[180:183], v[24:39]
    s_waitcnt lgkmcnt(0)
    v_mfma_f32_32x32x16_bf16 v[40:55], v[228:231], v[180:183], v[40:55]
    s_waitcnt vmcnt(5)
    s_barrier
    s_add_u32 m0, s31, 81920
    s_mov_b32 s35, 4194304
    buffer_load_dwordx4 v232, s[12:15], s35 offen lds
    s_add_u32 m0, s31, 90112
    s_mov_b32 s35, 4325376
    buffer_load_dwordx4 v232, s[12:15], s35 offen lds
    s_add_u32 m0, s31, 98304
    s_mov_b32 s35, 4456448
    buffer_load_dwordx4 v232, s[12:15], s35 offen lds
    s_add_u32 m0, s31, 106496
    s_mov_b32 s35, 4587520
    buffer_load_dwordx4 v232, s[12:15], s35 offen lds
    s_add_u32 m0, s31, 114688
    s_mov_b32 s35, 1024
    buffer_load_dwordx4 v251, s[16:19], s35 offen lds
    v_add_u32 v18, 0, v233
    v_add_u32 v19, 0, v234
    v_add_u32 v20, 0, v247
    v_add_u32 v21, 0, v248
    v_add_u32 v22, 0, v249
    v_add_u32 v23, 0, v250
    ds_read_b128 v[168:171], v20
    ds_read_b128 v[172:175], v21
    ds_read_b128 v[176:179], v22
    ds_read_b128 v[180:183], v23
    ds_read_b64_tr_b16 v[200:201], v18 offset:0
    ds_read_b64_tr_b16 v[202:203], v18 offset:2048
    ds_read_b64_tr_b16 v[204:205], v19 offset:0
    ds_read_b64_tr_b16 v[206:207], v19 offset:2048
    ds_read_b64_tr_b16 v[208:209], v18 offset:8192
    ds_read_b64_tr_b16 v[210:211], v18 offset:10240
    ds_read_b64_tr_b16 v[212:213], v19 offset:8192
    ds_read_b64_tr_b16 v[214:215], v19 offset:10240
    ds_read_b64_tr_b16 v[216:217], v18 offset:16384
    ds_read_b64_tr_b16 v[218:219], v18 offset:18432
    s_waitcnt lgkmcnt(6)
    ds_read_b64_tr_b16 v[220:221], v19 offset:16384
    ds_read_b64_tr_b16 v[222:223], v19 offset:18432
    ds_read_b64_tr_b16 v[224:225], v18 offset:24576
    ds_read_b64_tr_b16 v[226:227], v18 offset:26624
    ds_read_b64_tr_b16 v[228:229], v19 offset:24576
    ds_read_b64_tr_b16 v[230:231], v19 offset:26624
    s_waitcnt lgkmcnt(14)
    v_mfma_f32_32x32x16_bf16 v[24:39], v[200:203], v[168:171], v[24:39]
    s_waitcnt lgkmcnt(12)
    v_mfma_f32_32x32x16_bf16 v[40:55], v[204:207], v[168:171], v[40:55]
    s_waitcnt lgkmcnt(10)
    v_mfma_f32_32x32x16_bf16 v[24:39], v[208:211], v[172:175], v[24:39]
    s_waitcnt lgkmcnt(8)
    v_mfma_f32_32x32x16_bf16 v[40:55], v[212:215], v[172:175], v[40:55]
    s_waitcnt lgkmcnt(6)
    v_mfma_f32_32x32x16_bf16 v[24:39], v[216:219], v[176:179], v[24:39]
    s_waitcnt lgkmcnt(4)
    v_mfma_f32_32x32x16_bf16 v[40:55], v[220:223], v[176:179], v[40:55]
    s_waitcnt lgkmcnt(2)
    v_mfma_f32_32x32x16_bf16 v[24:39], v[224:227], v[180:183], v[24:39]
    s_waitcnt lgkmcnt(0)
    v_mfma_f32_32x32x16_bf16 v[40:55], v[228:231], v[180:183], v[40:55]
    s_waitcnt vmcnt(5)
    s_barrier
    v_add_u32 v18, 40960, v233
    v_add_u32 v19, 40960, v234
    v_add_u32 v20, 40960, v247
    v_add_u32 v21, 40960, v248
    v_add_u32 v22, 40960, v249
    v_add_u32 v23, 40960, v250
    ds_read_b128 v[168:171], v20
    ds_read_b128 v[172:175], v21
    ds_read_b128 v[176:179], v22
    ds_read_b128 v[180:183], v23
    ds_read_b64_tr_b16 v[200:201], v18 offset:0
    ds_read_b64_tr_b16 v[202:203], v18 offset:2048
    ds_read_b64_tr_b16 v[204:205], v19 offset:0
    ds_read_b64_tr_b16 v[206:207], v19 offset:2048
    ds_read_b64_tr_b16 v[208:209], v18 offset:8192
    ds_read_b64_tr_b16 v[210:211], v18 offset:10240
    ds_read_b64_tr_b16 v[212:213], v19 offset:8192
    ds_read_b64_tr_b16 v[214:215], v19 offset:10240
    ds_read_b64_tr_b16 v[216:217], v18 offset:16384
    ds_read_b64_tr_b16 v[218:219], v18 offset:18432
    s_waitcnt lgkmcnt(6)
    ds_read_b64_tr_b16 v[220:221], v19 offset:16384
    ds_read_b64_tr_b16 v[222:223], v19 offset:18432
    ds_read_b64_tr_b16 v[224:225], v18 offset:24576
    ds_read_b64_tr_b16 v[226:227], v18 offset:26624
    ds_read_b64_tr_b16 v[228:229], v19 offset:24576
    ds_read_b64_tr_b16 v[230:231], v19 offset:26624
    s_waitcnt lgkmcnt(14)
    v_mfma_f32_32x32x16_bf16 v[24:39], v[200:203], v[168:171], v[24:39]
    s_waitcnt lgkmcnt(12)
    v_mfma_f32_32x32x16_bf16 v[40:55], v[204:207], v[168:171], v[40:55]
    s_waitcnt lgkmcnt(10)
    v_mfma_f32_32x32x16_bf16 v[24:39], v[208:211], v[172:175], v[24:39]
    s_waitcnt lgkmcnt(8)
    v_mfma_f32_32x32x16_bf16 v[40:55], v[212:215], v[172:175], v[40:55]
    s_waitcnt lgkmcnt(6)
    v_mfma_f32_32x32x16_bf16 v[24:39], v[216:219], v[176:179], v[24:39]
    s_waitcnt lgkmcnt(4)
    v_mfma_f32_32x32x16_bf16 v[40:55], v[220:223], v[176:179], v[40:55]
    s_waitcnt lgkmcnt(2)
    v_mfma_f32_32x32x16_bf16 v[24:39], v[224:227], v[180:183], v[24:39]
    s_waitcnt lgkmcnt(0)
    v_mfma_f32_32x32x16_bf16 v[40:55], v[228:231], v[180:183], v[40:55]
    s_waitcnt vmcnt(0)
    s_barrier
    v_add_u32 v18, 81920, v233
    v_add_u32 v19, 81920, v234
    v_add_u32 v20, 81920, v247
    v_add_u32 v21, 81920, v248
    v_add_u32 v22, 81920, v249
    v_add_u32 v23, 81920, v250
    ds_read_b128 v[168:171], v20
    ds_read_b128 v[172:175], v21
    ds_read_b128 v[176:179], v22
    ds_read_b128 v[180:183], v23
    ds_read_b64_tr_b16 v[200:201], v18 offset:0
    ds_read_b64_tr_b16 v[202:203], v18 offset:2048
    ds_read_b64_tr_b16 v[204:205], v19 offset:0
    ds_read_b64_tr_b16 v[206:207], v19 offset:2048
    ds_read_b64_tr_b16 v[208:209], v18 offset:8192
    ds_read_b64_tr_b16 v[210:211], v18 offset:10240
    ds_read_b64_tr_b16 v[212:213], v19 offset:8192
    ds_read_b64_tr_b16 v[214:215], v19 offset:10240
    ds_read_b64_tr_b16 v[216:217], v18 offset:16384
    ds_read_b64_tr_b16 v[218:219], v18 offset:18432
    s_waitcnt lgkmcnt(6)
    ds_read_b64_tr_b16 v[220:221], v19 offset:16384
    ds_read_b64_tr_b16 v[222:223], v19 offset:18432
    ds_read_b64_tr_b16 v[224:225], v18 offset:24576
    ds_read_b64_tr_b16 v[226:227], v18 offset:26624
    ds_read_b64_tr_b16 v[228:229], v19 offset:24576
    ds_read_b64_tr_b16 v[230:231], v19 offset:26624
    s_waitcnt lgkmcnt(14)
    v_mfma_f32_32x32x16_bf16 v[24:39], v[200:203], v[168:171], v[24:39]
    s_waitcnt lgkmcnt(12)
    v_mfma_f32_32x32x16_bf16 v[40:55], v[204:207], v[168:171], v[40:55]
    s_waitcnt lgkmcnt(10)
    v_mfma_f32_32x32x16_bf16 v[24:39], v[208:211], v[172:175], v[24:39]
    s_waitcnt lgkmcnt(8)
    v_mfma_f32_32x32x16_bf16 v[40:55], v[212:215], v[172:175], v[40:55]
    s_waitcnt lgkmcnt(6)
    v_mfma_f32_32x32x16_bf16 v[24:39], v[216:219], v[176:179], v[24:39]
    s_waitcnt lgkmcnt(4)
    v_mfma_f32_32x32x16_bf16 v[40:55], v[220:223], v[176:179], v[40:55]
    s_waitcnt lgkmcnt(2)
    v_mfma_f32_32x32x16_bf16 v[24:39], v[224:227], v[180:183], v[24:39]
    s_waitcnt lgkmcnt(0)
    v_mfma_f32_32x32x16_bf16 v[40:55], v[228:231], v[180:183], v[40:55]
    s_barrier
    s_add_u32 m0, s31, 0
    s_add_u32 s35, s41, 0
    s_and_b32 s35, s35, 0x3ffff
    buffer_load_dwordx4 v15, s[8:11], s35 offen nt lds
    s_add_u32 m0, s31, 8192
    s_add_u32 s35, s41, 8192
    s_and_b32 s35, s35, 0x3ffff
    buffer_load_dwordx4 v15, s[8:11], s35 offen nt lds
    s_add_u32 m0, s31, 16384
    s_add_u32 s35, s41, 16384
    s_and_b32 s35, s35, 0x3ffff
    buffer_load_dwordx4 v15, s[8:11], s35 offen nt lds
    s_add_u32 m0, s31, 24576
    s_add_u32 s35, s41, 24576
    s_and_b32 s35, s35, 0x3ffff
    buffer_load_dwordx4 v15, s[8:11], s35 offen nt lds
    s_add_u32 m0, s31, 32768
    s_add_u32 s35, s41, 32768
    s_and_b32 s35, s35, 0x3ffff
    buffer_load_dwordx4 v14, s[4:7], s35 offen nt lds
    s_add_u32 m0, s31, 40960
    s_add_u32 s35, s41, 40960
    s_and_b32 s35, s35, 0x3ffff
    buffer_load_dwordx4 v14, s[4:7], s35 offen nt lds
    s_add_u32 m0, s31, 49152
    s_add_u32 s35, s41, 49152
    s_and_b32 s35, s35, 0x3ffff
    buffer_load_dwordx4 v14, s[4:7], s35 offen nt lds
    s_add_u32 m0, s31, 57344
    s_add_u32 s35, s41, 57344
    s_and_b32 s35, s35, 0x3ffff
    buffer_load_dwordx4 v14, s[4:7], s35 offen nt lds
    s_add_u32 m0, s31, 65536
    s_add_u32 s35, s41, 32768
    s_and_b32 s35, s35, 0x3ffff
    buffer_load_dwordx4 v15, s[8:11], s35 offen nt lds
    s_add_u32 m0, s31, 73728
    s_add_u32 s35, s41, 40960
    s_and_b32 s35, s35, 0x3ffff
    buffer_load_dwordx4 v15, s[8:11], s35 offen nt lds
    s_add_u32 m0, s31, 81920
    s_add_u32 s35, s41, 49152
    s_and_b32 s35, s35, 0x3ffff
    buffer_load_dwordx4 v15, s[8:11], s35 offen nt lds
    s_add_u32 m0, s31, 90112
    s_add_u32 s35, s41, 57344
    s_and_b32 s35, s35, 0x3ffff
    buffer_load_dwordx4 v15, s[8:11], s35 offen nt lds
    s_nop 7
    s_nop 7
    v_and_b32 v18, 15, v1
    v_cvt_pk_bf16_f32 v20, v24, v25
    v_cvt_pk_bf16_f32 v21, v26, v27
    s_lshl_b32 s32, s29, 3
    s_add_u32 s32, s32, 0
    v_xor_b32 v22, s32, v18
    v_lshl_add_u32 v22, v22, 4, v242
    ds_write_b64 v22, v[20:21]
    v_cvt_pk_bf16_f32 v20, v28, v29
    v_cvt_pk_bf16_f32 v21, v30, v31
    s_lshl_b32 s32, s29, 3
    s_add_u32 s32, s32, 1
    v_xor_b32 v22, s32, v18
    v_lshl_add_u32 v22, v22, 4, v242
    ds_write_b64 v22, v[20:21]
    v_cvt_pk_bf16_f32 v20, v32, v33
    v_cvt_pk_bf16_f32 v21, v34, v35
    s_lshl_b32 s32, s29, 3
    s_add_u32 s32, s32, 2
    v_xor_b32 v22, s32, v18
    v_lshl_add_u32 v22, v22, 4, v242
    ds_write_b64 v22, v[20:21]
    v_cvt_pk_bf16_f32 v20, v36, v37
    v_cvt_pk_bf16_f32 v21, v38, v39
    s_lshl_b32 s32, s29, 3
    s_add_u32 s32, s32, 3
    v_xor_b32 v22, s32, v18
    v_lshl_add_u32 v22, v22, 4, v242
    ds_write_b64 v22, v[20:21]
    v_cvt_pk_bf16_f32 v20, v40, v41
    v_cvt_pk_bf16_f32 v21, v42, v43
    s_lshl_b32 s32, s29, 3
    s_add_u32 s32, s32, 4
    v_xor_b32 v22, s32, v18
    v_lshl_add_u32 v22, v22, 4, v242
    ds_write_b64 v22, v[20:21]
    v_cvt_pk_bf16_f32 v20, v44, v45
    v_cvt_pk_bf16_f32 v21, v46, v47
    s_lshl_b32 s32, s29, 3
    s_add_u32 s32, s32, 5
    v_xor_b32 v22, s32, v18
    v_lshl_add_u32 v22, v22, 4, v242
    ds_write_b64 v22, v[20:21]
    v_cvt_pk_bf16_f32 v20, v48, v49
    v_cvt_pk_bf16_f32 v21, v50, v51
    s_lshl_b32 s32, s29, 3
    s_add_u32 s32, s32, 6
    v_xor_b32 v22, s32, v18
    v_lshl_add_u32 v22, v22, 4, v242
    ds_write_b64 v22, v[20:21]
    v_cvt_pk_bf16_f32 v20, v52, v53
    v_cvt_pk_bf16_f32 v21, v54, v55
    s_lshl_b32 s32, s29, 3
    s_add_u32 s32, s32, 7
    v_xor_b32 v22, s32, v18
    v_lshl_add_u32 v22, v22, 4, v242
    ds_write_b64 v22, v[20:21]
    s_waitcnt lgkmcnt(0)
    s_barrier
    s_lshl_b32 s32, s30, 13
    s_add_u32 s32, s32, 98304
    v_add_u32 v18, s32, v2
    ds_read_b128 v[24:27], v18
    v_add_u32 v18, s32, v3
    ds_read_b128 v[28:31], v18
    v_add_u32 v18, s32, v4
    ds_read_b128 v[32:35], v18
    v_add_u32 v18, s32, v5
    ds_read_b128 v[36:39], v18
    v_add_u32 v18, s32, v6
    ds_read_b128 v[40:43], v18
    v_add_u32 v18, s32, v7
    ds_read_b128 v[44:47], v18
    v_add_u32 v18, s32, v8
    ds_read_b128 v[48:51], v18
    v_add_u32 v18, s32, v9
    ds_read_b128 v[52:55], v18
    v_mov_b32 v16, 0xff7fffff
    v_mov_b32 v17, 0
    v_mov_b32 v56, 0
    v_mov_b32 v57, 0
    v_mov_b32 v58, 0
    v_mov_b32 v59, 0
    v_mov_b32 v60, 0
    v_mov_b32 v61, 0
    v_mov_b32 v62, 0
    v_mov_b32 v63, 0
    v_mov_b32 v64, 0
    v_mov_b32 v65, 0
    v_mov_b32 v66, 0
    v_mov_b32 v67, 0
    v_mov_b32 v68, 0
    v_mov_b32 v69, 0
    v_mov_b32 v70, 0
    v_mov_b32 v71, 0
    v_mov_b32 v72, 0
    v_mov_b32 v73, 0
    v_mov_b32 v74, 0
    v_mov_b32 v75, 0
    v_mov_b32 v76, 0
    v_mov_b32 v77, 0
    v_mov_b32 v78, 0
    v_mov_b32 v79, 0
    v_mov_b32 v80, 0
    v_mov_b32 v81, 0
    v_mov_b32 v82, 0
    v_mov_b32 v83, 0
    v_mov_b32 v84, 0
    v_mov_b32 v85, 0
    v_mov_b32 v86, 0
    v_mov_b32 v87, 0
    v_mov_b32 v88, 0
    v_mov_b32 v89, 0
    v_mov_b32 v90, 0
    v_mov_b32 v91, 0
    v_mov_b32 v92, 0
    v_mov_b32 v93, 0
    v_mov_b32 v94, 0
    v_mov_b32 v95, 0
    v_mov_b32 v96, 0
    v_mov_b32 v97, 0
    v_mov_b32 v98, 0
    v_mov_b32 v99, 0
    v_mov_b32 v100, 0
    v_mov_b32 v101, 0
    v_mov_b32 v102, 0
    v_mov_b32 v103, 0
    v_mov_b32 v104, 0
    v_mov_b32 v105, 0
    v_mov_b32 v106, 0
    v_mov_b32 v107, 0
    v_mov_b32 v108, 0
    v_mov_b32 v109, 0
    v_mov_b32 v110, 0
    v_mov_b32 v111, 0
    v_mov_b32 v112, 0
    v_mov_b32 v113, 0
    v_mov_b32 v114, 0
    v_mov_b32 v115, 0
    v_mov_b32 v116, 0
    v_mov_b32 v117, 0
    v_mov_b32 v118, 0
    v_mov_b32 v119, 0
    s_mov_b32 s42, 147456
    s_cmp_eq_u32 s29, 0
    s_cselect_b32 s42, 131072, s42
    s_mov_b32 s43, 16384
    s_cmp_eq_u32 s29, 0
    s_cselect_b32 s43, 0, s43
    v_add_u32 v2, s42, v2
    v_add_u32 v3, s42, v3
    v_add_u32 v4, s42, v4
    v_add_u32 v5, s42, v5
    v_add_u32 v6, s42, v6
    v_add_u32 v7, s42, v7
    v_add_u32 v8, s42, v8
    v_add_u32 v9, s42, v9
    v_add_u32 v10, s43, v10
    v_add_u32 v11, s43, v11
    v_add_u32 v12, s43, v12
    v_add_u32 v13, s43, v13
    s_waitcnt lgkmcnt(0)
    s_barrier
    s_add_u32 m0, s31, 98304
    s_add_u32 s35, s41, 65536
    s_and_b32 s35, s35, 0x3ffff
    buffer_load_dwordx4 v14, s[4:7], s35 offen nt lds
    s_add_u32 m0, s31, 106496
    s_add_u32 s35, s41, 73728
    s_and_b32 s35, s35, 0x3ffff
    buffer_load_dwordx4 v14, s[4:7], s35 offen nt lds
    s_add_u32 m0, s31, 114688
    s_add_u32 s35, s41, 81920
    s_and_b32 s35, s35, 0x3ffff
    buffer_load_dwordx4 v14, s[4:7], s35 offen nt lds
    s_add_u32 m0, s31, 122880
    s_add_u32 s35, s41, 90112
    s_and_b32 s35, s35, 0x3ffff
    buffer_load_dwordx4 v14, s[4:7], s35 offen nt lds
    ds_read_b128 v[168:171], v2 offset:0
    ds_read_b128 v[172:175], v3 offset:0
    ds_read_b128 v[176:179], v4 offset:0
    ds_read_b128 v[180:183], v5 offset:0
    ds_read_b128 v[184:187], v6 offset:0
    ds_read_b128 v[188:191], v7 offset:0
    ds_read_b128 v[192:195], v8 offset:0
    ds_read_b128 v[196:199], v9 offset:0
    s_waitcnt lgkmcnt(7)
    v_mfma_f32_32x32x16_bf16 v[120:135], v[168:171], v[24:27], 0
    ds_read_b128 v[168:171], v2 offset:8192
    s_waitcnt lgkmcnt(7)
    v_mfma_f32_32x32x16_bf16 v[120:135], v[172:175], v[28:31], v[120:135]
    ds_read_b128 v[172:175], v3 offset:8192
    s_waitcnt lgkmcnt(7)
    v_mfma_f32_32x32x16_bf16 v[120:135], v[176:179], v[32:35], v[120:135]
    ds_read_b128 v[176:179], v4 offset:8192
    s_waitcnt lgkmcnt(7)
    v_mfma_f32_32x32x16_bf16 v[120:135], v[180:183], v[36:39], v[120:135]
    ds_read_b128 v[180:183], v5 offset:8192
    s_waitcnt lgkmcnt(7)
    v_mfma_f32_32x32x16_bf16 v[120:135], v[184:187], v[40:43], v[120:135]
    ds_read_b128 v[184:187], v6 offset:8192
    s_waitcnt lgkmcnt(7)
    v_mfma_f32_32x32x16_bf16 v[120:135], v[188:191], v[44:47], v[120:135]
    ds_read_b128 v[188:191], v7 offset:8192
    s_waitcnt lgkmcnt(7)
    v_mfma_f32_32x32x16_bf16 v[120:135], v[192:195], v[48:51], v[120:135]
    ds_read_b128 v[192:195], v8 offset:8192
    s_waitcnt lgkmcnt(7)
    v_mfma_f32_32x32x16_bf16 v[120:135], v[196:199], v[52:55], v[120:135]
    ds_read_b128 v[196:199], v9 offset:8192
    s_waitcnt lgkmcnt(7)
    v_mfma_f32_32x32x16_bf16 v[136:151], v[168:171], v[24:27], 0
    s_waitcnt lgkmcnt(6)
    v_mfma_f32_32x32x16_bf16 v[136:151], v[172:175], v[28:31], v[136:151]
    s_waitcnt lgkmcnt(5)
    v_mfma_f32_32x32x16_bf16 v[136:151], v[176:179], v[32:35], v[136:151]
    s_waitcnt lgkmcnt(4)
    v_mfma_f32_32x32x16_bf16 v[136:151], v[180:183], v[36:39], v[136:151]
    s_waitcnt lgkmcnt(3)
    v_mfma_f32_32x32x16_bf16 v[136:151], v[184:187], v[40:43], v[136:151]
    s_waitcnt lgkmcnt(2)
    v_mfma_f32_32x32x16_bf16 v[136:151], v[188:191], v[44:47], v[136:151]
    s_waitcnt lgkmcnt(1)
    v_mfma_f32_32x32x16_bf16 v[136:151], v[192:195], v[48:51], v[136:151]
    s_waitcnt lgkmcnt(0)
    v_mfma_f32_32x32x16_bf16 v[136:151], v[196:199], v[52:55], v[136:151]
    s_waitcnt vmcnt(12)
    s_barrier
    s_add_u32 m0, s31, 131072
    s_add_u32 s35, s41, 65536
    s_and_b32 s35, s35, 0x3ffff
    buffer_load_dwordx4 v15, s[8:11], s35 offen nt lds
    s_add_u32 m0, s31, 139264
    s_add_u32 s35, s41, 73728
    s_and_b32 s35, s35, 0x3ffff
    buffer_load_dwordx4 v15, s[8:11], s35 offen nt lds
    s_add_u32 m0, s31, 147456
    s_add_u32 s35, s41, 81920
    s_and_b32 s35, s35, 0x3ffff
    buffer_load_dwordx4 v15, s[8:11], s35 offen nt lds
    s_add_u32 m0, s31, 155648
    s_add_u32 s35, s41, 90112
    s_and_b32 s35, s35, 0x3ffff
    buffer_load_dwordx4 v15, s[8:11], s35 offen nt lds
    ds_read_b64_tr_b16 v[200:201], v10 offset:0
    ds_read_b64_tr_b16 v[202:203], v10 offset:2048
    ds_read_b64_tr_b16 v[204:205], v11 offset:0
    ds_read_b64_tr_b16 v[206:207], v11 offset:2048
    ds_read_b64_tr_b16 v[208:209], v12 offset:0
    ds_read_b64_tr_b16 v[210:211], v12 offset:2048
    ds_read_b64_tr_b16 v[212:213], v13 offset:0
    ds_read_b64_tr_b16 v[214:215], v13 offset:2048
    ds_read_b64_tr_b16 v[216:217], v10 offset:4096
    ds_read_b64_tr_b16 v[218:219], v10 offset:6144
    ds_read_b64_tr_b16 v[220:221], v11 offset:4096
    ds_read_b64_tr_b16 v[222:223], v11 offset:6144
    s_nop 7
    v_max3_f32 v18, v120, v121, v122
    v_max3_f32 v18, v18, v123, v124
    v_max3_f32 v18, v18, v125, v126
    v_max3_f32 v18, v18, v127, v128
    v_max3_f32 v18, v18, v129, v130
    v_max3_f32 v18, v18, v131, v132
    v_max3_f32 v18, v18, v133, v134
    v_max3_f32 v18, v18, v135, v136
    v_max3_f32 v18, v18, v137, v138
    v_max3_f32 v18, v18, v139, v140
    v_max3_f32 v18, v18, v141, v142
    v_max3_f32 v18, v18, v143, v144
    v_max3_f32 v18, v18, v145, v146
    v_max3_f32 v18, v18, v147, v148
    v_max3_f32 v18, v18, v149, v150
    v_max_f32 v18, v18, v151
    v_mov_b32 v19, v18
    s_nop 1
    v_permlane32_swap_b32 v18, v19
    v_max_f32 v18, v18, v19
    v_mul_f32 v18, s36, v18
    v_add_f32 v19, 0x41000000, v16
    v_cmp_gt_f32 vcc, v18, v19
    s_nop 4
    s_cbranch_vccz L_skip0
    v_max_f32 v18, v18, v16
    v_sub_f32 v19, v16, v18
    v_exp_f32 v19, v19
    v_mov_b32 v16, v18
    s_nop 0
    v_mul_f32 v17, v17, v19
    v_mul_f32 v56, v56, v19
    v_mul_f32 v57, v57, v19
    v_mul_f32 v58, v58, v19
    v_mul_f32 v59, v59, v19
    v_mul_f32 v60, v60, v19
    v_mul_f32 v61, v61, v19
    v_mul_f32 v62, v62, v19
    v_mul_f32 v63, v63, v19
    v_mul_f32 v64, v64, v19
    v_mul_f32 v65, v65, v19
    v_mul_f32 v66, v66, v19
    v_mul_f32 v67, v67, v19
    v_mul_f32 v68, v68, v19
    v_mul_f32 v69, v69, v19
    v_mul_f32 v70, v70, v19
    v_mul_f32 v71, v71, v19
    v_mul_f32 v72, v72, v19
    v_mul_f32 v73, v73, v19
    v_mul_f32 v74, v74, v19
    v_mul_f32 v75, v75, v19
    v_mul_f32 v76, v76, v19
    v_mul_f32 v77, v77, v19
    v_mul_f32 v78, v78, v19
    v_mul_f32 v79, v79, v19
    v_mul_f32 v80, v80, v19
    v_mul_f32 v81, v81, v19
    v_mul_f32 v82, v82, v19
    v_mul_f32 v83, v83, v19
    v_mul_f32 v84, v84, v19
    v_mul_f32 v85, v85, v19
    v_mul_f32 v86, v86, v19
    v_mul_f32 v87, v87, v19
    v_mul_f32 v88, v88, v19
    v_mul_f32 v89, v89, v19
    v_mul_f32 v90, v90, v19
    v_mul_f32 v91, v91, v19
    v_mul_f32 v92, v92, v19
    v_mul_f32 v93, v93, v19
    v_mul_f32 v94, v94, v19
    v_mul_f32 v95, v95, v19
    v_mul_f32 v96, v96, v19
    v_mul_f32 v97, v97, v19
    v_mul_f32 v98, v98, v19
    v_mul_f32 v99, v99, v19
    v_mul_f32 v100, v100, v19
    v_mul_f32 v101, v101, v19
    v_mul_f32 v102, v102, v19
    v_mul_f32 v103, v103, v19
    v_mul_f32 v104, v104, v19
    v_mul_f32 v105, v105, v19
    v_mul_f32 v106, v106, v19
    v_mul_f32 v107, v107, v19
    v_mul_f32 v108, v108, v19
    v_mul_f32 v109, v109, v19
    v_mul_f32 v110, v110, v19
    v_mul_f32 v111, v111, v19
    v_mul_f32 v112, v112, v19
    v_mul_f32 v113, v113, v19
    v_mul_f32 v114, v114, v19
    v_mul_f32 v115, v115, v19
    v_mul_f32 v116, v116, v19
    v_mul_f32 v117, v117, v19
    v_mul_f32 v118, v118, v19
    v_mul_f32 v119, v119, v19
L_skip0:
    v_fma_f32 v120, v120, s36, -v16
    v_fma_f32 v121, v121, s36, -v16
    v_fma_f32 v122, v122, s36, -v16
    v_fma_f32 v123, v123, s36, -v16
    v_fma_f32 v124, v124, s36, -v16
    v_fma_f32 v125, v125, s36, -v16
    v_fma_f32 v126, v126, s36, -v16
    v_fma_f32 v127, v127, s36, -v16
    v_fma_f32 v128, v128, s36, -v16
    v_fma_f32 v129, v129, s36, -v16
    v_fma_f32 v130, v130, s36, -v16
    v_fma_f32 v131, v131, s36, -v16
    v_fma_f32 v132, v132, s36, -v16
    v_fma_f32 v133, v133, s36, -v16
    v_fma_f32 v134, v134, s36, -v16
    v_fma_f32 v135, v135, s36, -v16
    v_fma_f32 v136, v136, s36, -v16
    v_fma_f32 v137, v137, s36, -v16
    v_fma_f32 v138, v138, s36, -v16
    v_fma_f32 v139, v139, s36, -v16
    v_fma_f32 v140, v140, s36, -v16
    v_fma_f32 v141, v141, s36, -v16
    v_fma_f32 v142, v142, s36, -v16
    v_fma_f32 v143, v143, s36, -v16
    v_fma_f32 v144, v144, s36, -v16
    v_fma_f32 v145, v145, s36, -v16
    v_fma_f32 v146, v146, s36, -v16
    v_fma_f32 v147, v147, s36, -v16
    v_fma_f32 v148, v148, s36, -v16
    v_fma_f32 v149, v149, s36, -v16
    v_fma_f32 v150, v150, s36, -v16
    v_fma_f32 v151, v151, s36, -v16
    v_exp_f32 v120, v120
    v_exp_f32 v121, v121
    v_exp_f32 v122, v122
    v_exp_f32 v123, v123
    v_exp_f32 v124, v124
    v_exp_f32 v125, v125
    v_exp_f32 v126, v126
    v_exp_f32 v127, v127
    v_exp_f32 v128, v128
    v_exp_f32 v129, v129
    v_exp_f32 v130, v130
    v_exp_f32 v131, v131
    v_exp_f32 v132, v132
    v_exp_f32 v133, v133
    v_exp_f32 v134, v134
    v_exp_f32 v135, v135
    v_exp_f32 v136, v136
    v_exp_f32 v137, v137
    v_exp_f32 v138, v138
    v_exp_f32 v139, v139
    v_exp_f32 v140, v140
    v_exp_f32 v141, v141
    v_exp_f32 v142, v142
    v_exp_f32 v143, v143
    v_exp_f32 v144, v144
    v_exp_f32 v145, v145
    v_exp_f32 v146, v146
    v_exp_f32 v147, v147
    v_exp_f32 v148, v148
    v_exp_f32 v149, v149
    v_exp_f32 v150, v150
    v_exp_f32 v151, v151
    s_nop 0
    v_cvt_pk_bf16_f32 v152, v120, v121
    v_cvt_pk_bf16_f32 v153, v122, v123
    v_cvt_pk_bf16_f32 v154, v124, v125
    v_cvt_pk_bf16_f32 v155, v126, v127
    v_cvt_pk_bf16_f32 v156, v128, v129
    v_cvt_pk_bf16_f32 v157, v130, v131
    v_cvt_pk_bf16_f32 v158, v132, v133
    v_cvt_pk_bf16_f32 v159, v134, v135
    v_cvt_pk_bf16_f32 v160, v136, v137
    v_cvt_pk_bf16_f32 v161, v138, v139
    v_cvt_pk_bf16_f32 v162, v140, v141
    v_cvt_pk_bf16_f32 v163, v142, v143
    v_cvt_pk_bf16_f32 v164, v144, v145
    v_cvt_pk_bf16_f32 v165, v146, v147
    v_cvt_pk_bf16_f32 v166, v148, v149
    v_cvt_pk_bf16_f32 v167, v150, v151
    v_add_f32 v20, v120, v121
    v_add_f32 v21, v122, v123
    v_add_f32 v20, v20, v124
    v_add_f32 v21, v21, v125
    v_add_f32 v20, v20, v126
    v_add_f32 v21, v21, v127
    v_add_f32 v20, v20, v128
    v_add_f32 v21, v21, v129
    v_add_f32 v20, v20, v130
    v_add_f32 v21, v21, v131
    v_add_f32 v20, v20, v132
    v_add_f32 v21, v21, v133
    v_add_f32 v20, v20, v134
    v_add_f32 v21, v21, v135
    v_add_f32 v20, v20, v136
    v_add_f32 v21, v21, v137
    v_add_f32 v20, v20, v138
    v_add_f32 v21, v21, v139
    v_add_f32 v20, v20, v140
    v_add_f32 v21, v21, v141
    v_add_f32 v20, v20, v142
    v_add_f32 v21, v21, v143
    v_add_f32 v20, v20, v144
    v_add_f32 v21, v21, v145
    v_add_f32 v20, v20, v146
    v_add_f32 v21, v21, v147
    v_add_f32 v20, v20, v148
    v_add_f32 v21, v21, v149
    v_add_f32 v20, v20, v150
    v_add_f32 v21, v21, v151
    v_add_f32 v17, v17, v20
    v_add_f32 v17, v17, v21
    s_waitcnt lgkmcnt(10)
    v_mfma_f32_32x32x16_bf16 v[56:71], v[200:203], v[152:155], v[56:71]
    ds_read_b64_tr_b16 v[224:225], v12 offset:4096
    ds_read_b64_tr_b16 v[226:227], v12 offset:6144
    s_waitcnt lgkmcnt(10)
    v_mfma_f32_32x32x16_bf16 v[72:87], v[204:207], v[152:155], v[72:87]
    ds_read_b64_tr_b16 v[228:229], v13 offset:4096
    ds_read_b64_tr_b16 v[230:231], v13 offset:6144
    s_waitcnt lgkmcnt(10)
    v_mfma_f32_32x32x16_bf16 v[88:103], v[208:211], v[152:155], v[88:103]
    ds_read_b64_tr_b16 v[200:201], v10 offset:8192
    ds_read_b64_tr_b16 v[202:203], v10 offset:10240
    s_waitcnt lgkmcnt(10)
    v_mfma_f32_32x32x16_bf16 v[104:119], v[212:215], v[152:155], v[104:119]
    ds_read_b64_tr_b16 v[204:205], v11 offset:8192
    ds_read_b64_tr_b16 v[206:207], v11 offset:10240
    s_waitcnt lgkmcnt(10)
    v_mfma_f32_32x32x16_bf16 v[56:71], v[216:219], v[156:159], v[56:71]
    ds_read_b64_tr_b16 v[208:209], v12 offset:8192
    ds_read_b64_tr_b16 v[210:211], v12 offset:10240
    s_waitcnt lgkmcnt(10)
    v_mfma_f32_32x32x16_bf16 v[72:87], v[220:223], v[156:159], v[72:87]
    ds_read_b64_tr_b16 v[212:213], v13 offset:8192
    ds_read_b64_tr_b16 v[214:215], v13 offset:10240
    s_waitcnt lgkmcnt(10)
    v_mfma_f32_32x32x16_bf16 v[88:103], v[224:227], v[156:159], v[88:103]
    ds_read_b64_tr_b16 v[216:217], v10 offset:12288
    ds_read_b64_tr_b16 v[218:219], v10 offset:14336
    s_waitcnt lgkmcnt(10)
    v_mfma_f32_32x32x16_bf16 v[104:119], v[228:231], v[156:159], v[104:119]
    ds_read_b64_tr_b16 v[220:221], v11 offset:12288
    ds_read_b64_tr_b16 v[222:223], v11 offset:14336
    s_waitcnt lgkmcnt(10)
    v_mfma_f32_32x32x16_bf16 v[56:71], v[200:203], v[160:163], v[56:71]
    ds_read_b64_tr_b16 v[224:225], v12 offset:12288
    ds_read_b64_tr_b16 v[226:227], v12 offset:14336
    s_waitcnt lgkmcnt(10)
    v_mfma_f32_32x32x16_bf16 v[72:87], v[204:207], v[160:163], v[72:87]
    ds_read_b64_tr_b16 v[228:229], v13 offset:12288
    ds_read_b64_tr_b16 v[230:231], v13 offset:14336
    s_waitcnt lgkmcnt(10)
    v_mfma_f32_32x32x16_bf16 v[88:103], v[208:211], v[160:163], v[88:103]
    s_waitcnt lgkmcnt(8)
    v_mfma_f32_32x32x16_bf16 v[104:119], v[212:215], v[160:163], v[104:119]
    s_waitcnt lgkmcnt(6)
    v_mfma_f32_32x32x16_bf16 v[56:71], v[216:219], v[164:167], v[56:71]
    s_waitcnt lgkmcnt(4)
    v_mfma_f32_32x32x16_bf16 v[72:87], v[220:223], v[164:167], v[72:87]
    s_waitcnt lgkmcnt(2)
    v_mfma_f32_32x32x16_bf16 v[88:103], v[224:227], v[164:167], v[88:103]
    s_waitcnt lgkmcnt(0)
    v_mfma_f32_32x32x16_bf16 v[104:119], v[228:231], v[164:167], v[104:119]
    s_mov_b32 s42, -98304
    s_cmp_eq_u32 s29, 0
    s_cselect_b32 s42, -98304, s42
    s_mov_b32 s43, 65536
    s_cmp_eq_u32 s29, 0
    s_cselect_b32 s43, 65536, s43
    v_add_u32 v2, s42, v2
    v_add_u32 v3, s42, v3
    v_add_u32 v4, s42, v4
    v_add_u32 v5, s42, v5
    v_add_u32 v6, s42, v6
    v_add_u32 v7, s42, v7
    v_add_u32 v8, s42, v8
    v_add_u32 v9, s42, v9
    v_add_u32 v10, s43, v10
    v_add_u32 v11, s43, v11
    v_add_u32 v12, s43, v12
    v_add_u32 v13, s43, v13
    s_waitcnt vmcnt(12)
    s_barrier
    s_add_u32 m0, s31, 0
    s_add_u32 s35, s41, 98304
    s_and_b32 s35, s35, 0x3ffff
    buffer_load_dwordx4 v14, s[4:7], s35 offen nt lds
    s_add_u32 m0, s31, 8192
    s_add_u32 s35, s41, 106496
    s_and_b32 s35, s35, 0x3ffff
    buffer_load_dwordx4 v14, s[4:7], s35 offen nt lds
    s_add_u32 m0, s31, 16384
    s_add_u32 s35, s41, 114688
    s_and_b32 s35, s35, 0x3ffff
    buffer_load_dwordx4 v14, s[4:7], s35 offen nt lds
    s_add_u32 m0, s31, 24576
    s_add_u32 s35, s41, 122880
    s_and_b32 s35, s35, 0x3ffff
    buffer_load_dwordx4 v14, s[4:7], s35 offen nt lds
    ds_read_b128 v[168:171], v2 offset:0
    ds_read_b128 v[172:175], v3 offset:0
    ds_read_b128 v[176:179], v4 offset:0
    ds_read_b128 v[180:183], v5 offset:0
    ds_read_b128 v[184:187], v6 offset:0
    ds_read_b128 v[188:191], v7 offset:0
    ds_read_b128 v[192:195], v8 offset:0
    ds_read_b128 v[196:199], v9 offset:0
    s_waitcnt lgkmcnt(7)
    v_mfma_f32_32x32x16_bf16 v[120:135], v[168:171], v[24:27], 0
    ds_read_b128 v[168:171], v2 offset:8192
    s_waitcnt lgkmcnt(7)
    v_mfma_f32_32x32x16_bf16 v[120:135], v[172:175], v[28:31], v[120:135]
    ds_read_b128 v[172:175], v3 offset:8192
    s_waitcnt lgkmcnt(7)
    v_mfma_f32_32x32x16_bf16 v[120:135], v[176:179], v[32:35], v[120:135]
    ds_read_b128 v[176:179], v4 offset:8192
    s_waitcnt lgkmcnt(7)
    v_mfma_f32_32x32x16_bf16 v[120:135], v[180:183], v[36:39], v[120:135]
    ds_read_b128 v[180:183], v5 offset:8192
    s_waitcnt lgkmcnt(7)
    v_mfma_f32_32x32x16_bf16 v[120:135], v[184:187], v[40:43], v[120:135]
    ds_read_b128 v[184:187], v6 offset:8192
    s_waitcnt lgkmcnt(7)
    v_mfma_f32_32x32x16_bf16 v[120:135], v[188:191], v[44:47], v[120:135]
    ds_read_b128 v[188:191], v7 offset:8192
    s_waitcnt lgkmcnt(7)
    v_mfma_f32_32x32x16_bf16 v[120:135], v[192:195], v[48:51], v[120:135]
    ds_read_b128 v[192:195], v8 offset:8192
    s_waitcnt lgkmcnt(7)
    v_mfma_f32_32x32x16_bf16 v[120:135], v[196:199], v[52:55], v[120:135]
    ds_read_b128 v[196:199], v9 offset:8192
    s_waitcnt lgkmcnt(7)
    v_mfma_f32_32x32x16_bf16 v[136:151], v[168:171], v[24:27], 0
    s_waitcnt lgkmcnt(6)
    v_mfma_f32_32x32x16_bf16 v[136:151], v[172:175], v[28:31], v[136:151]
    s_waitcnt lgkmcnt(5)
    v_mfma_f32_32x32x16_bf16 v[136:151], v[176:179], v[32:35], v[136:151]
    s_waitcnt lgkmcnt(4)
    v_mfma_f32_32x32x16_bf16 v[136:151], v[180:183], v[36:39], v[136:151]
    s_waitcnt lgkmcnt(3)
    v_mfma_f32_32x32x16_bf16 v[136:151], v[184:187], v[40:43], v[136:151]
    s_waitcnt lgkmcnt(2)
    v_mfma_f32_32x32x16_bf16 v[136:151], v[188:191], v[44:47], v[136:151]
    s_waitcnt lgkmcnt(1)
    v_mfma_f32_32x32x16_bf16 v[136:151], v[192:195], v[48:51], v[136:151]
    s_waitcnt lgkmcnt(0)
    v_mfma_f32_32x32x16_bf16 v[136:151], v[196:199], v[52:55], v[136:151]
    s_waitcnt vmcnt(12)
    s_barrier
    s_add_u32 m0, s31, 32768
    s_add_u32 s35, s41, 98304
    s_and_b32 s35, s35, 0x3ffff
    buffer_load_dwordx4 v15, s[8:11], s35 offen nt lds
    s_add_u32 m0, s31, 40960
    s_add_u32 s35, s41, 106496
    s_and_b32 s35, s35, 0x3ffff
    buffer_load_dwordx4 v15, s[8:11], s35 offen nt lds
    s_add_u32 m0, s31, 49152
    s_add_u32 s35, s41, 114688
    s_and_b32 s35, s35, 0x3ffff
    buffer_load_dwordx4 v15, s[8:11], s35 offen nt lds
    s_add_u32 m0, s31, 57344
    s_add_u32 s35, s41, 122880
    s_and_b32 s35, s35, 0x3ffff
    buffer_load_dwordx4 v15, s[8:11], s35 offen nt lds
    ds_read_b64_tr_b16 v[200:201], v10 offset:0
    ds_read_b64_tr_b16 v[202:203], v10 offset:2048
    ds_read_b64_tr_b16 v[204:205], v11 offset:0
    ds_read_b64_tr_b16 v[206:207], v11 offset:2048
    ds_read_b64_tr_b16 v[208:209], v12 offset:0
    ds_read_b64_tr_b16 v[210:211], v12 offset:2048
    ds_read_b64_tr_b16 v[212:213], v13 offset:0
    ds_read_b64_tr_b16 v[214:215], v13 offset:2048
    ds_read_b64_tr_b16 v[216:217], v10 offset:4096
    ds_read_b64_tr_b16 v[218:219], v10 offset:6144
    ds_read_b64_tr_b16 v[220:221], v11 offset:4096
    ds_read_b64_tr_b16 v[222:223], v11 offset:6144
    s_nop 7
    v_max3_f32 v18, v120, v121, v122
    v_max3_f32 v18, v18, v123, v124
    v_max3_f32 v18, v18, v125, v126
    v_max3_f32 v18, v18, v127, v128
    v_max3_f32 v18, v18, v129, v130
    v_max3_f32 v18, v18, v131, v132
    v_max3_f32 v18, v18, v133, v134
    v_max3_f32 v18, v18, v135, v136
    v_max3_f32 v18, v18, v137, v138
    v_max3_f32 v18, v18, v139, v140
    v_max3_f32 v18, v18, v141, v142
    v_max3_f32 v18, v18, v143, v144
    v_max3_f32 v18, v18, v145, v146
    v_max3_f32 v18, v18, v147, v148
    v_max3_f32 v18, v18, v149, v150
    v_max_f32 v18, v18, v151
    v_mov_b32 v19, v18
    s_nop 1
    v_permlane32_swap_b32 v18, v19
    v_max_f32 v18, v18, v19
    v_mul_f32 v18, s36, v18
    v_add_f32 v19, 0x41000000, v16
    v_cmp_gt_f32 vcc, v18, v19
    s_nop 4
    s_cbranch_vccz L_skip1
    v_max_f32 v18, v18, v16
    v_sub_f32 v19, v16, v18
    v_exp_f32 v19, v19
    v_mov_b32 v16, v18
    s_nop 0
    v_mul_f32 v17, v17, v19
    v_mul_f32 v56, v56, v19
    v_mul_f32 v57, v57, v19
    v_mul_f32 v58, v58, v19
    v_mul_f32 v59, v59, v19
    v_mul_f32 v60, v60, v19
    v_mul_f32 v61, v61, v19
    v_mul_f32 v62, v62, v19
    v_mul_f32 v63, v63, v19
    v_mul_f32 v64, v64, v19
    v_mul_f32 v65, v65, v19
    v_mul_f32 v66, v66, v19
    v_mul_f32 v67, v67, v19
    v_mul_f32 v68, v68, v19
    v_mul_f32 v69, v69, v19
    v_mul_f32 v70, v70, v19
    v_mul_f32 v71, v71, v19
    v_mul_f32 v72, v72, v19
    v_mul_f32 v73, v73, v19
    v_mul_f32 v74, v74, v19
    v_mul_f32 v75, v75, v19
    v_mul_f32 v76, v76, v19
    v_mul_f32 v77, v77, v19
    v_mul_f32 v78, v78, v19
    v_mul_f32 v79, v79, v19
    v_mul_f32 v80, v80, v19
    v_mul_f32 v81, v81, v19
    v_mul_f32 v82, v82, v19
    v_mul_f32 v83, v83, v19
    v_mul_f32 v84, v84, v19
    v_mul_f32 v85, v85, v19
    v_mul_f32 v86, v86, v19
    v_mul_f32 v87, v87, v19
    v_mul_f32 v88, v88, v19
    v_mul_f32 v89, v89, v19
    v_mul_f32 v90, v90, v19
    v_mul_f32 v91, v91, v19
    v_mul_f32 v92, v92, v19
    v_mul_f32 v93, v93, v19
    v_mul_f32 v94, v94, v19
    v_mul_f32 v95, v95, v19
    v_mul_f32 v96, v96, v19
    v_mul_f32 v97, v97, v19
    v_mul_f32 v98, v98, v19
    v_mul_f32 v99, v99, v19
    v_mul_f32 v100, v100, v19
    v_mul_f32 v101, v101, v19
    v_mul_f32 v102, v102, v19
    v_mul_f32 v103, v103, v19
    v_mul_f32 v104, v104, v19
    v_mul_f32 v105, v105, v19
    v_mul_f32 v106, v106, v19
    v_mul_f32 v107, v107, v19
    v_mul_f32 v108, v108, v19
    v_mul_f32 v109, v109, v19
    v_mul_f32 v110, v110, v19
    v_mul_f32 v111, v111, v19
    v_mul_f32 v112, v112, v19
    v_mul_f32 v113, v113, v19
    v_mul_f32 v114, v114, v19
    v_mul_f32 v115, v115, v19
    v_mul_f32 v116, v116, v19
    v_mul_f32 v117, v117, v19
    v_mul_f32 v118, v118, v19
    v_mul_f32 v119, v119, v19
L_skip1:
    v_fma_f32 v120, v120, s36, -v16
    v_fma_f32 v121, v121, s36, -v16
    v_fma_f32 v122, v122, s36, -v16
    v_fma_f32 v123, v123, s36, -v16
    v_fma_f32 v124, v124, s36, -v16
    v_fma_f32 v125, v125, s36, -v16
    v_fma_f32 v126, v126, s36, -v16
    v_fma_f32 v127, v127, s36, -v16
    v_fma_f32 v128, v128, s36, -v16
    v_fma_f32 v129, v129, s36, -v16
    v_fma_f32 v130, v130, s36, -v16
    v_fma_f32 v131, v131, s36, -v16
    v_fma_f32 v132, v132, s36, -v16
    v_fma_f32 v133, v133, s36, -v16
    v_fma_f32 v134, v134, s36, -v16
    v_fma_f32 v135, v135, s36, -v16
    v_fma_f32 v136, v136, s36, -v16
    v_fma_f32 v137, v137, s36, -v16
    v_fma_f32 v138, v138, s36, -v16
    v_fma_f32 v139, v139, s36, -v16
    v_fma_f32 v140, v140, s36, -v16
    v_fma_f32 v141, v141, s36, -v16
    v_fma_f32 v142, v142, s36, -v16
    v_fma_f32 v143, v143, s36, -v16
    v_fma_f32 v144, v144, s36, -v16
    v_fma_f32 v145, v145, s36, -v16
    v_fma_f32 v146, v146, s36, -v16
    v_fma_f32 v147, v147, s36, -v16
    v_fma_f32 v148, v148, s36, -v16
    v_fma_f32 v149, v149, s36, -v16
    v_fma_f32 v150, v150, s36, -v16
    v_fma_f32 v151, v151, s36, -v16
    v_exp_f32 v120, v120
    v_exp_f32 v121, v121
    v_exp_f32 v122, v122
    v_exp_f32 v123, v123
    v_exp_f32 v124, v124
    v_exp_f32 v125, v125
    v_exp_f32 v126, v126
    v_exp_f32 v127, v127
    v_exp_f32 v128, v128
    v_exp_f32 v129, v129
    v_exp_f32 v130, v130
    v_exp_f32 v131, v131
    v_exp_f32 v132, v132
    v_exp_f32 v133, v133
    v_exp_f32 v134, v134
    v_exp_f32 v135, v135
    v_exp_f32 v136, v136
    v_exp_f32 v137, v137
    v_exp_f32 v138, v138
    v_exp_f32 v139, v139
    v_exp_f32 v140, v140
    v_exp_f32 v141, v141
    v_exp_f32 v142, v142
    v_exp_f32 v143, v143
    v_exp_f32 v144, v144
    v_exp_f32 v145, v145
    v_exp_f32 v146, v146
    v_exp_f32 v147, v147
    v_exp_f32 v148, v148
    v_exp_f32 v149, v149
    v_exp_f32 v150, v150
    v_exp_f32 v151, v151
    s_nop 0
    v_cvt_pk_bf16_f32 v152, v120, v121
    v_cvt_pk_bf16_f32 v153, v122, v123
    v_cvt_pk_bf16_f32 v154, v124, v125
    v_cvt_pk_bf16_f32 v155, v126, v127
    v_cvt_pk_bf16_f32 v156, v128, v129
    v_cvt_pk_bf16_f32 v157, v130, v131
    v_cvt_pk_bf16_f32 v158, v132, v133
    v_cvt_pk_bf16_f32 v159, v134, v135
    v_cvt_pk_bf16_f32 v160, v136, v137
    v_cvt_pk_bf16_f32 v161, v138, v139
    v_cvt_pk_bf16_f32 v162, v140, v141
    v_cvt_pk_bf16_f32 v163, v142, v143
    v_cvt_pk_bf16_f32 v164, v144, v145
    v_cvt_pk_bf16_f32 v165, v146, v147
    v_cvt_pk_bf16_f32 v166, v148, v149
    v_cvt_pk_bf16_f32 v167, v150, v151
    v_add_f32 v20, v120, v121
    v_add_f32 v21, v122, v123
    v_add_f32 v20, v20, v124
    v_add_f32 v21, v21, v125
    v_add_f32 v20, v20, v126
    v_add_f32 v21, v21, v127
    v_add_f32 v20, v20, v128
    v_add_f32 v21, v21, v129
    v_add_f32 v20, v20, v130
    v_add_f32 v21, v21, v131
    v_add_f32 v20, v20, v132
    v_add_f32 v21, v21, v133
    v_add_f32 v20, v20, v134
    v_add_f32 v21, v21, v135
    v_add_f32 v20, v20, v136
    v_add_f32 v21, v21, v137
    v_add_f32 v20, v20, v138
    v_add_f32 v21, v21, v139
    v_add_f32 v20, v20, v140
    v_add_f32 v21, v21, v141
    v_add_f32 v20, v20, v142
    v_add_f32 v21, v21, v143
    v_add_f32 v20, v20, v144
    v_add_f32 v21, v21, v145
    v_add_f32 v20, v20, v146
    v_add_f32 v21, v21, v147
    v_add_f32 v20, v20, v148
    v_add_f32 v21, v21, v149
    v_add_f32 v20, v20, v150
    v_add_f32 v21, v21, v151
    v_add_f32 v17, v17, v20
    v_add_f32 v17, v17, v21
    s_waitcnt lgkmcnt(10)
    v_mfma_f32_32x32x16_bf16 v[56:71], v[200:203], v[152:155], v[56:71]
    ds_read_b64_tr_b16 v[224:225], v12 offset:4096
    ds_read_b64_tr_b16 v[226:227], v12 offset:6144
    s_waitcnt lgkmcnt(10)
    v_mfma_f32_32x32x16_bf16 v[72:87], v[204:207], v[152:155], v[72:87]
    ds_read_b64_tr_b16 v[228:229], v13 offset:4096
    ds_read_b64_tr_b16 v[230:231], v13 offset:6144
    s_waitcnt lgkmcnt(10)
    v_mfma_f32_32x32x16_bf16 v[88:103], v[208:211], v[152:155], v[88:103]
    ds_read_b64_tr_b16 v[200:201], v10 offset:8192
    ds_read_b64_tr_b16 v[202:203], v10 offset:10240
    s_waitcnt lgkmcnt(10)
    v_mfma_f32_32x32x16_bf16 v[104:119], v[212:215], v[152:155], v[104:119]
    ds_read_b64_tr_b16 v[204:205], v11 offset:8192
    ds_read_b64_tr_b16 v[206:207], v11 offset:10240
    s_waitcnt lgkmcnt(10)
    v_mfma_f32_32x32x16_bf16 v[56:71], v[216:219], v[156:159], v[56:71]
    ds_read_b64_tr_b16 v[208:209], v12 offset:8192
    ds_read_b64_tr_b16 v[210:211], v12 offset:10240
    s_waitcnt lgkmcnt(10)
    v_mfma_f32_32x32x16_bf16 v[72:87], v[220:223], v[156:159], v[72:87]
    ds_read_b64_tr_b16 v[212:213], v13 offset:8192
    ds_read_b64_tr_b16 v[214:215], v13 offset:10240
    s_waitcnt lgkmcnt(10)
    v_mfma_f32_32x32x16_bf16 v[88:103], v[224:227], v[156:159], v[88:103]
    ds_read_b64_tr_b16 v[216:217], v10 offset:12288
    ds_read_b64_tr_b16 v[218:219], v10 offset:14336
    s_waitcnt lgkmcnt(10)
    v_mfma_f32_32x32x16_bf16 v[104:119], v[228:231], v[156:159], v[104:119]
    ds_read_b64_tr_b16 v[220:221], v11 offset:12288
    ds_read_b64_tr_b16 v[222:223], v11 offset:14336
    s_waitcnt lgkmcnt(10)
    v_mfma_f32_32x32x16_bf16 v[56:71], v[200:203], v[160:163], v[56:71]
    ds_read_b64_tr_b16 v[224:225], v12 offset:12288
    ds_read_b64_tr_b16 v[226:227], v12 offset:14336
    s_waitcnt lgkmcnt(10)
    v_mfma_f32_32x32x16_bf16 v[72:87], v[204:207], v[160:163], v[72:87]
    ds_read_b64_tr_b16 v[228:229], v13 offset:12288
    ds_read_b64_tr_b16 v[230:231], v13 offset:14336
    s_waitcnt lgkmcnt(10)
    v_mfma_f32_32x32x16_bf16 v[88:103], v[208:211], v[160:163], v[88:103]
    s_waitcnt lgkmcnt(8)
    v_mfma_f32_32x32x16_bf16 v[104:119], v[212:215], v[160:163], v[104:119]
    s_waitcnt lgkmcnt(6)
    v_mfma_f32_32x32x16_bf16 v[56:71], v[216:219], v[164:167], v[56:71]
    s_waitcnt lgkmcnt(4)
    v_mfma_f32_32x32x16_bf16 v[72:87], v[220:223], v[164:167], v[72:87]
    s_waitcnt lgkmcnt(2)
    v_mfma_f32_32x32x16_bf16 v[88:103], v[224:227], v[164:167], v[88:103]
    s_waitcnt lgkmcnt(0)
    v_mfma_f32_32x32x16_bf16 v[104:119], v[228:231], v[164:167], v[104:119]
    s_mov_b32 s42, 65536
    s_cmp_eq_u32 s29, 0
    s_cselect_b32 s42, 65536, s42
    s_mov_b32 s43, 65536
    s_cmp_eq_u32 s29, 0
    s_cselect_b32 s43, 65536, s43
    v_add_u32 v2, s42, v2
    v_add_u32 v3, s42, v3
    v_add_u32 v4, s42, v4
    v_add_u32 v5, s42, v5
    v_add_u32 v6, s42, v6
    v_add_u32 v7, s42, v7
    v_add_u32 v8, s42, v8
    v_add_u32 v9, s42, v9
    v_add_u32 v10, s43, v10
    v_add_u32 v11, s43, v11
    v_add_u32 v12, s43, v12
    v_add_u32 v13, s43, v13
    s_waitcnt vmcnt(12)
    s_barrier
    s_add_u32 m0, s31, 65536
    s_add_u32 s35, s41, 131072
    s_and_b32 s35, s35, 0x3ffff
    buffer_load_dwordx4 v14, s[4:7], s35 offen nt lds
    s_add_u32 m0, s31, 73728
    s_add_u32 s35, s41, 139264
    s_and_b32 s35, s35, 0x3ffff
    buffer_load_dwordx4 v14, s[4:7], s35 offen nt lds
    s_add_u32 m0, s31, 81920
    s_add_u32 s35, s41, 147456
    s_and_b32 s35, s35, 0x3ffff
    buffer_load_dwordx4 v14, s[4:7], s35 offen nt lds
    s_add_u32 m0, s31, 90112
    s_add_u32 s35, s41, 155648
    s_and_b32 s35, s35, 0x3ffff
    buffer_load_dwordx4 v14, s[4:7], s35 offen nt lds
    s_lshr_b32 s32, s2, 4
    s_mul_i32 s32, s32, 18432
    s_add_u32 s32, s32, s31
    buffer_load_dwordx4 v[252:255], v243, s[20:23], s32 offen
    s_add_u32 s32, s32, 8192
    buffer_load_dwordx4 v[252:255], v243, s[20:23], s32 offen
    s_add_u32 s32, s32, 8192
    s_and_b32 s33, s31, 0x7ff
    s_sub_u32 s32, s32, s31
    s_add_u32 s32, s32, s33
    buffer_load_dwordx4 v[252:255], v243, s[20:23], s32 offen
    ds_read_b128 v[168:171], v2 offset:0
    ds_read_b128 v[172:175], v3 offset:0
    ds_read_b128 v[176:179], v4 offset:0
    ds_read_b128 v[180:183], v5 offset:0
    ds_read_b128 v[184:187], v6 offset:0
    ds_read_b128 v[188:191], v7 offset:0
    ds_read_b128 v[192:195], v8 offset:0
    ds_read_b128 v[196:199], v9 offset:0
    s_waitcnt lgkmcnt(7)
    v_mfma_f32_32x32x16_bf16 v[120:135], v[168:171], v[24:27], 0
    ds_read_b128 v[168:171], v2 offset:8192
    s_waitcnt lgkmcnt(7)
    v_mfma_f32_32x32x16_bf16 v[120:135], v[172:175], v[28:31], v[120:135]
    ds_read_b128 v[172:175], v3 offset:8192
    s_waitcnt lgkmcnt(7)
    v_mfma_f32_32x32x16_bf16 v[120:135], v[176:179], v[32:35], v[120:135]
    ds_read_b128 v[176:179], v4 offset:8192
    s_waitcnt lgkmcnt(7)
    v_mfma_f32_32x32x16_bf16 v[120:135], v[180:183], v[36:39], v[120:135]
    ds_read_b128 v[180:183], v5 offset:8192
    s_waitcnt lgkmcnt(7)
    v_mfma_f32_32x32x16_bf16 v[120:135], v[184:187], v[40:43], v[120:135]
    ds_read_b128 v[184:187], v6 offset:8192
    s_waitcnt lgkmcnt(7)
    v_mfma_f32_32x32x16_bf16 v[120:135], v[188:191], v[44:47], v[120:135]
    ds_read_b128 v[188:191], v7 offset:8192
    s_waitcnt lgkmcnt(7)
    v_mfma_f32_32x32x16_bf16 v[120:135], v[192:195], v[48:51], v[120:135]
    ds_read_b128 v[192:195], v8 offset:8192
    s_waitcnt lgkmcnt(7)
    v_mfma_f32_32x32x16_bf16 v[120:135], v[196:199], v[52:55], v[120:135]
    ds_read_b128 v[196:199], v9 offset:8192
    s_waitcnt lgkmcnt(7)
    v_mfma_f32_32x32x16_bf16 v[136:151], v[168:171], v[24:27], 0
    s_waitcnt lgkmcnt(6)
    v_mfma_f32_32x32x16_bf16 v[136:151], v[172:175], v[28:31], v[136:151]
    s_waitcnt lgkmcnt(5)
    v_mfma_f32_32x32x16_bf16 v[136:151], v[176:179], v[32:35], v[136:151]
    s_waitcnt lgkmcnt(4)
    v_mfma_f32_32x32x16_bf16 v[136:151], v[180:183], v[36:39], v[136:151]
    s_waitcnt lgkmcnt(3)
    v_mfma_f32_32x32x16_bf16 v[136:151], v[184:187], v[40:43], v[136:151]
    s_waitcnt lgkmcnt(2)
    v_mfma_f32_32x32x16_bf16 v[136:151], v[188:191], v[44:47], v[136:151]
    s_waitcnt lgkmcnt(1)
    v_mfma_f32_32x32x16_bf16 v[136:151], v[192:195], v[48:51], v[136:151]
    s_waitcnt lgkmcnt(0)
    v_mfma_f32_32x32x16_bf16 v[136:151], v[196:199], v[52:55], v[136:151]
    s_waitcnt vmcnt(15)
    s_barrier
    s_add_u32 m0, s31, 98304
    s_add_u32 s35, s41, 131072
    s_and_b32 s35, s35, 0x3ffff
    buffer_load_dwordx4 v15, s[8:11], s35 offen nt lds
    s_add_u32 m0, s31, 106496
    s_add_u32 s35, s41, 139264
    s_and_b32 s35, s35, 0x3ffff
    buffer_load_dwordx4 v15, s[8:11], s35 offen nt lds
    s_add_u32 m0, s31, 114688
    s_add_u32 s35, s41, 147456
    s_and_b32 s35, s35, 0x3ffff
    buffer_load_dwordx4 v15, s[8:11], s35 offen nt lds
    s_add_u32 m0, s31, 122880
    s_add_u32 s35, s41, 155648
    s_and_b32 s35, s35, 0x3ffff
    buffer_load_dwordx4 v15, s[8:11], s35 offen nt lds
    ds_read_b64_tr_b16 v[200:201], v10 offset:0
    ds_read_b64_tr_b16 v[202:203], v10 offset:2048
    ds_read_b64_tr_b16 v[204:205], v11 offset:0
    ds_read_b64_tr_b16 v[206:207], v11 offset:2048
    ds_read_b64_tr_b16 v[208:209], v12 offset:0
    ds_read_b64_tr_b16 v[210:211], v12 offset:2048
    ds_read_b64_tr_b16 v[212:213], v13 offset:0
    ds_read_b64_tr_b16 v[214:215], v13 offset:2048
    ds_read_b64_tr_b16 v[216:217], v10 offset:4096
    ds_read_b64_tr_b16 v[218:219], v10 offset:6144
    ds_read_b64_tr_b16 v[220:221], v11 offset:4096
    ds_read_b64_tr_b16 v[222:223], v11 offset:6144
    s_nop 7
    v_max3_f32 v18, v120, v121, v122
    v_max3_f32 v18, v18, v123, v124
    v_max3_f32 v18, v18, v125, v126
    v_max3_f32 v18, v18, v127, v128
    v_max3_f32 v18, v18, v129, v130
    v_max3_f32 v18, v18, v131, v132
    v_max3_f32 v18, v18, v133, v134
    v_max3_f32 v18, v18, v135, v136
    v_max3_f32 v18, v18, v137, v138
    v_max3_f32 v18, v18, v139, v140
    v_max3_f32 v18, v18, v141, v142
    v_max3_f32 v18, v18, v143, v144
    v_max3_f32 v18, v18, v145, v146
    v_max3_f32 v18, v18, v147, v148
    v_max3_f32 v18, v18, v149, v150
    v_max_f32 v18, v18, v151
    v_mov_b32 v19, v18
    s_nop 1
    v_permlane32_swap_b32 v18, v19
    v_max_f32 v18, v18, v19
    v_mul_f32 v18, s36, v18
    v_add_f32 v19, 0x41000000, v16
    v_cmp_gt_f32 vcc, v18, v19
    s_nop 4
    s_cbranch_vccz L_skip2
    v_max_f32 v18, v18, v16
    v_sub_f32 v19, v16, v18
    v_exp_f32 v19, v19
    v_mov_b32 v16, v18
    s_nop 0
    v_mul_f32 v17, v17, v19
    v_mul_f32 v56, v56, v19
    v_mul_f32 v57, v57, v19
    v_mul_f32 v58, v58, v19
    v_mul_f32 v59, v59, v19
    v_mul_f32 v60, v60, v19
    v_mul_f32 v61, v61, v19
    v_mul_f32 v62, v62, v19
    v_mul_f32 v63, v63, v19
    v_mul_f32 v64, v64, v19
    v_mul_f32 v65, v65, v19
    v_mul_f32 v66, v66, v19
    v_mul_f32 v67, v67, v19
    v_mul_f32 v68, v68, v19
    v_mul_f32 v69, v69, v19
    v_mul_f32 v70, v70, v19
    v_mul_f32 v71, v71, v19
    v_mul_f32 v72, v72, v19
    v_mul_f32 v73, v73, v19
    v_mul_f32 v74, v74, v19
    v_mul_f32 v75, v75, v19
    v_mul_f32 v76, v76, v19
    v_mul_f32 v77, v77, v19
    v_mul_f32 v78, v78, v19
    v_mul_f32 v79, v79, v19
    v_mul_f32 v80, v80, v19
    v_mul_f32 v81, v81, v19
    v_mul_f32 v82, v82, v19
    v_mul_f32 v83, v83, v19
    v_mul_f32 v84, v84, v19
    v_mul_f32 v85, v85, v19
    v_mul_f32 v86, v86, v19
    v_mul_f32 v87, v87, v19
    v_mul_f32 v88, v88, v19
    v_mul_f32 v89, v89, v19
    v_mul_f32 v90, v90, v19
    v_mul_f32 v91, v91, v19
    v_mul_f32 v92, v92, v19
    v_mul_f32 v93, v93, v19
    v_mul_f32 v94, v94, v19
    v_mul_f32 v95, v95, v19
    v_mul_f32 v96, v96, v19
    v_mul_f32 v97, v97, v19
    v_mul_f32 v98, v98, v19
    v_mul_f32 v99, v99, v19
    v_mul_f32 v100, v100, v19
    v_mul_f32 v101, v101, v19
    v_mul_f32 v102, v102, v19
    v_mul_f32 v103, v103, v19
    v_mul_f32 v104, v104, v19
    v_mul_f32 v105, v105, v19
    v_mul_f32 v106, v106, v19
    v_mul_f32 v107, v107, v19
    v_mul_f32 v108, v108, v19
    v_mul_f32 v109, v109, v19
    v_mul_f32 v110, v110, v19
    v_mul_f32 v111, v111, v19
    v_mul_f32 v112, v112, v19
    v_mul_f32 v113, v113, v19
    v_mul_f32 v114, v114, v19
    v_mul_f32 v115, v115, v19
    v_mul_f32 v116, v116, v19
    v_mul_f32 v117, v117, v19
    v_mul_f32 v118, v118, v19
    v_mul_f32 v119, v119, v19
L_skip2:
    v_fma_f32 v120, v120, s36, -v16
    v_fma_f32 v121, v121, s36, -v16
    v_fma_f32 v122, v122, s36, -v16
    v_fma_f32 v123, v123, s36, -v16
    v_fma_f32 v124, v124, s36, -v16
    v_fma_f32 v125, v125, s36, -v16
    v_fma_f32 v126, v126, s36, -v16
    v_fma_f32 v127, v127, s36, -v16
    v_fma_f32 v128, v128, s36, -v16
    v_fma_f32 v129, v129, s36, -v16
    v_fma_f32 v130, v130, s36, -v16
    v_fma_f32 v131, v131, s36, -v16
    v_fma_f32 v132, v132, s36, -v16
    v_fma_f32 v133, v133, s36, -v16
    v_fma_f32 v134, v134, s36, -v16
    v_fma_f32 v135, v135, s36, -v16
    v_fma_f32 v136, v136, s36, -v16
    v_fma_f32 v137, v137, s36, -v16
    v_fma_f32 v138, v138, s36, -v16
    v_fma_f32 v139, v139, s36, -v16
    v_fma_f32 v140, v140, s36, -v16
    v_fma_f32 v141, v141, s36, -v16
    v_fma_f32 v142, v142, s36, -v16
    v_fma_f32 v143, v143, s36, -v16
    v_fma_f32 v144, v144, s36, -v16
    v_fma_f32 v145, v145, s36, -v16
    v_fma_f32 v146, v146, s36, -v16
    v_fma_f32 v147, v147, s36, -v16
    v_fma_f32 v148, v148, s36, -v16
    v_fma_f32 v149, v149, s36, -v16
    v_fma_f32 v150, v150, s36, -v16
    v_fma_f32 v151, v151, s36, -v16
    v_exp_f32 v120, v120
    v_exp_f32 v121, v121
    v_exp_f32 v122, v122
    v_exp_f32 v123, v123
    v_exp_f32 v124, v124
    v_exp_f32 v125, v125
    v_exp_f32 v126, v126
    v_exp_f32 v127, v127
    v_exp_f32 v128, v128
    v_exp_f32 v129, v129
    v_exp_f32 v130, v130
    v_exp_f32 v131, v131
    v_exp_f32 v132, v132
    v_exp_f32 v133, v133
    v_exp_f32 v134, v134
    v_exp_f32 v135, v135
    v_exp_f32 v136, v136
    v_exp_f32 v137, v137
    v_exp_f32 v138, v138
    v_exp_f32 v139, v139
    v_exp_f32 v140, v140
    v_exp_f32 v141, v141
    v_exp_f32 v142, v142
    v_exp_f32 v143, v143
    v_exp_f32 v144, v144
    v_exp_f32 v145, v145
    v_exp_f32 v146, v146
    v_exp_f32 v147, v147
    v_exp_f32 v148, v148
    v_exp_f32 v149, v149
    v_exp_f32 v150, v150
    v_exp_f32 v151, v151
    s_nop 0
    v_cvt_pk_bf16_f32 v152, v120, v121
    v_cvt_pk_bf16_f32 v153, v122, v123
    v_cvt_pk_bf16_f32 v154, v124, v125
    v_cvt_pk_bf16_f32 v155, v126, v127
    v_cvt_pk_bf16_f32 v156, v128, v129
    v_cvt_pk_bf16_f32 v157, v130, v131
    v_cvt_pk_bf16_f32 v158, v132, v133
    v_cvt_pk_bf16_f32 v159, v134, v135
    v_cvt_pk_bf16_f32 v160, v136, v137
    v_cvt_pk_bf16_f32 v161, v138, v139
    v_cvt_pk_bf16_f32 v162, v140, v141
    v_cvt_pk_bf16_f32 v163, v142, v143
    v_cvt_pk_bf16_f32 v164, v144, v145
    v_cvt_pk_bf16_f32 v165, v146, v147
    v_cvt_pk_bf16_f32 v166, v148, v149
    v_cvt_pk_bf16_f32 v167, v150, v151
    v_add_f32 v20, v120, v121
    v_add_f32 v21, v122, v123
    v_add_f32 v20, v20, v124
    v_add_f32 v21, v21, v125
    v_add_f32 v20, v20, v126
    v_add_f32 v21, v21, v127
    v_add_f32 v20, v20, v128
    v_add_f32 v21, v21, v129
    v_add_f32 v20, v20, v130
    v_add_f32 v21, v21, v131
    v_add_f32 v20, v20, v132
    v_add_f32 v21, v21, v133
    v_add_f32 v20, v20, v134
    v_add_f32 v21, v21, v135
    v_add_f32 v20, v20, v136
    v_add_f32 v21, v21, v137
    v_add_f32 v20, v20, v138
    v_add_f32 v21, v21, v139
    v_add_f32 v20, v20, v140
    v_add_f32 v21, v21, v141
    v_add_f32 v20, v20, v142
    v_add_f32 v21, v21, v143
    v_add_f32 v20, v20, v144
    v_add_f32 v21, v21, v145
    v_add_f32 v20, v20, v146
    v_add_f32 v21, v21, v147
    v_add_f32 v20, v20, v148
    v_add_f32 v21, v21, v149
    v_add_f32 v20, v20, v150
    v_add_f32 v21, v21, v151
    v_add_f32 v17, v17, v20
    v_add_f32 v17, v17, v21
    s_waitcnt lgkmcnt(10)
    v_mfma_f32_32x32x16_bf16 v[56:71], v[200:203], v[152:155], v[56:71]
    ds_read_b64_tr_b16 v[224:225], v12 offset:4096
    ds_read_b64_tr_b16 v[226:227], v12 offset:6144
    s_waitcnt lgkmcnt(10)
    v_mfma_f32_32x32x16_bf16 v[72:87], v[204:207], v[152:155], v[72:87]
    ds_read_b64_tr_b16 v[228:229], v13 offset:4096
    ds_read_b64_tr_b16 v[230:231], v13 offset:6144
    s_waitcnt lgkmcnt(10)
    v_mfma_f32_32x32x16_bf16 v[88:103], v[208:211], v[152:155], v[88:103]
    ds_read_b64_tr_b16 v[200:201], v10 offset:8192
    ds_read_b64_tr_b16 v[202:203], v10 offset:10240
    s_waitcnt lgkmcnt(10)
    v_mfma_f32_32x32x16_bf16 v[104:119], v[212:215], v[152:155], v[104:119]
    ds_read_b64_tr_b16 v[204:205], v11 offset:8192
    ds_read_b64_tr_b16 v[206:207], v11 offset:10240
    s_waitcnt lgkmcnt(10)
    v_mfma_f32_32x32x16_bf16 v[56:71], v[216:219], v[156:159], v[56:71]
    ds_read_b64_tr_b16 v[208:209], v12 offset:8192
    ds_read_b64_tr_b16 v[210:211], v12 offset:10240
    s_waitcnt lgkmcnt(10)
    v_mfma_f32_32x32x16_bf16 v[72:87], v[220:223], v[156:159], v[72:87]
    ds_read_b64_tr_b16 v[212:213], v13 offset:8192
    ds_read_b64_tr_b16 v[214:215], v13 offset:10240
    s_waitcnt lgkmcnt(10)
    v_mfma_f32_32x32x16_bf16 v[88:103], v[224:227], v[156:159], v[88:103]
    ds_read_b64_tr_b16 v[216:217], v10 offset:12288
    ds_read_b64_tr_b16 v[218:219], v10 offset:14336
    s_waitcnt lgkmcnt(10)
    v_mfma_f32_32x32x16_bf16 v[104:119], v[228:231], v[156:159], v[104:119]
    ds_read_b64_tr_b16 v[220:221], v11 offset:12288
    ds_read_b64_tr_b16 v[222:223], v11 offset:14336
    s_waitcnt lgkmcnt(10)
    v_mfma_f32_32x32x16_bf16 v[56:71], v[200:203], v[160:163], v[56:71]
    ds_read_b64_tr_b16 v[224:225], v12 offset:12288
    ds_read_b64_tr_b16 v[226:227], v12 offset:14336
    s_waitcnt lgkmcnt(10)
    v_mfma_f32_32x32x16_bf16 v[72:87], v[204:207], v[160:163], v[72:87]
    ds_read_b64_tr_b16 v[228:229], v13 offset:12288
    ds_read_b64_tr_b16 v[230:231], v13 offset:14336
    s_waitcnt lgkmcnt(10)
    v_mfma_f32_32x32x16_bf16 v[88:103], v[208:211], v[160:163], v[88:103]
    s_waitcnt lgkmcnt(8)
    v_mfma_f32_32x32x16_bf16 v[104:119], v[212:215], v[160:163], v[104:119]
    s_waitcnt lgkmcnt(6)
    v_mfma_f32_32x32x16_bf16 v[56:71], v[216:219], v[164:167], v[56:71]
    s_waitcnt lgkmcnt(4)
    v_mfma_f32_32x32x16_bf16 v[72:87], v[220:223], v[164:167], v[72:87]
    s_waitcnt lgkmcnt(2)
    v_mfma_f32_32x32x16_bf16 v[88:103], v[224:227], v[164:167], v[88:103]
    s_waitcnt lgkmcnt(0)
    v_mfma_f32_32x32x16_bf16 v[104:119], v[228:231], v[164:167], v[104:119]
    s_mov_b32 s42, -98304
    s_cmp_eq_u32 s29, 0
    s_cselect_b32 s42, -98304, s42
    s_mov_b32 s43, -98304
    s_cmp_eq_u32 s29, 0
    s_cselect_b32 s43, -98304, s43
    v_add_u32 v2, s42, v2
    v_add_u32 v3, s42, v3
    v_add_u32 v4, s42, v4
    v_add_u32 v5, s42, v5
    v_add_u32 v6, s42, v6
    v_add_u32 v7, s42, v7
    v_add_u32 v8, s42, v8
    v_add_u32 v9, s42, v9
    v_add_u32 v10, s43, v10
    v_add_u32 v11, s43, v11
    v_add_u32 v12, s43, v12
    v_add_u32 v13, s43, v13
    s_waitcnt vmcnt(15)
    s_barrier
    s_add_u32 m0, s31, 131072
    s_add_u32 s35, s41, 163840
    s_and_b32 s35, s35, 0x3ffff
    buffer_load_dwordx4 v14, s[4:7], s35 offen nt lds
    s_add_u32 m0, s31, 139264
    s_add_u32 s35, s41, 172032
    s_and_b32 s35, s35, 0x3ffff
    buffer_load_dwordx4 v14, s[4:7], s35 offen nt lds
    s_add_u32 m0, s31, 147456
    s_add_u32 s35, s41, 180224
    s_and_b32 s35, s35, 0x3ffff
    buffer_load_dwordx4 v14, s[4:7], s35 offen nt lds
    s_add_u32 m0, s31, 155648
    s_add_u32 s35, s41, 188416
    s_and_b32 s35, s35, 0x3ffff
    buffer_load_dwordx4 v14, s[4:7], s35 offen nt lds
    ds_read_b128 v[168:171], v2 offset:0
    ds_read_b128 v[172:175], v3 offset:0
    ds_read_b128 v[176:179], v4 offset:0
    ds_read_b128 v[180:183], v5 offset:0
    ds_read_b128 v[184:187], v6 offset:0
    ds_read_b128 v[188:191], v7 offset:0
    ds_read_b128 v[192:195], v8 offset:0
    ds_read_b128 v[196:199], v9 offset:0
    s_waitcnt lgkmcnt(7)
    v_mfma_f32_32x32x16_bf16 v[120:135], v[168:171], v[24:27], 0
    ds_read_b128 v[168:171], v2 offset:8192
    s_waitcnt lgkmcnt(7)
    v_mfma_f32_32x32x16_bf16 v[120:135], v[172:175], v[28:31], v[120:135]
    ds_read_b128 v[172:175], v3 offset:8192
    s_waitcnt lgkmcnt(7)
    v_mfma_f32_32x32x16_bf16 v[120:135], v[176:179], v[32:35], v[120:135]
    ds_read_b128 v[176:179], v4 offset:8192
    s_waitcnt lgkmcnt(7)
    v_mfma_f32_32x32x16_bf16 v[120:135], v[180:183], v[36:39], v[120:135]
    ds_read_b128 v[180:183], v5 offset:8192
    s_waitcnt lgkmcnt(7)
    v_mfma_f32_32x32x16_bf16 v[120:135], v[184:187], v[40:43], v[120:135]
    ds_read_b128 v[184:187], v6 offset:8192
    s_waitcnt lgkmcnt(7)
    v_mfma_f32_32x32x16_bf16 v[120:135], v[188:191], v[44:47], v[120:135]
    ds_read_b128 v[188:191], v7 offset:8192
    s_waitcnt lgkmcnt(7)
    v_mfma_f32_32x32x16_bf16 v[120:135], v[192:195], v[48:51], v[120:135]
    ds_read_b128 v[192:195], v8 offset:8192
    s_waitcnt lgkmcnt(7)
    v_mfma_f32_32x32x16_bf16 v[120:135], v[196:199], v[52:55], v[120:135]
    ds_read_b128 v[196:199], v9 offset:8192
    s_waitcnt lgkmcnt(7)
    v_mfma_f32_32x32x16_bf16 v[136:151], v[168:171], v[24:27], 0
    s_waitcnt lgkmcnt(6)
    v_mfma_f32_32x32x16_bf16 v[136:151], v[172:175], v[28:31], v[136:151]
    s_waitcnt lgkmcnt(5)
    v_mfma_f32_32x32x16_bf16 v[136:151], v[176:179], v[32:35], v[136:151]
    s_waitcnt lgkmcnt(4)
    v_mfma_f32_32x32x16_bf16 v[136:151], v[180:183], v[36:39], v[136:151]
    s_waitcnt lgkmcnt(3)
    v_mfma_f32_32x32x16_bf16 v[136:151], v[184:187], v[40:43], v[136:151]
    s_waitcnt lgkmcnt(2)
    v_mfma_f32_32x32x16_bf16 v[136:151], v[188:191], v[44:47], v[136:151]
    s_waitcnt lgkmcnt(1)
    v_mfma_f32_32x32x16_bf16 v[136:151], v[192:195], v[48:51], v[136:151]
    s_waitcnt lgkmcnt(0)
    v_mfma_f32_32x32x16_bf16 v[136:151], v[196:199], v[52:55], v[136:151]
    s_waitcnt vmcnt(15)
    s_barrier
    s_add_u32 m0, s31, 0
    s_add_u32 s35, s41, 163840
    s_and_b32 s35, s35, 0x3ffff
    buffer_load_dwordx4 v15, s[8:11], s35 offen nt lds
    s_add_u32 m0, s31, 8192
    s_add_u32 s35, s41, 172032
    s_and_b32 s35, s35, 0x3ffff
    buffer_load_dwordx4 v15, s[8:11], s35 offen nt lds
    s_add_u32 m0, s31, 16384
    s_add_u32 s35, s41, 180224
    s_and_b32 s35, s35, 0x3ffff
    buffer_load_dwordx4 v15, s[8:11], s35 offen nt lds
    s_add_u32 m0, s31, 24576
    s_add_u32 s35, s41, 188416
    s_and_b32 s35, s35, 0x3ffff
    buffer_load_dwordx4 v15, s[8:11], s35 offen nt lds
    ds_read_b64_tr_b16 v[200:201], v10 offset:0
    ds_read_b64_tr_b16 v[202:203], v10 offset:2048
    ds_read_b64_tr_b16 v[204:205], v11 offset:0
    ds_read_b64_tr_b16 v[206:207], v11 offset:2048
    ds_read_b64_tr_b16 v[208:209], v12 offset:0
    ds_read_b64_tr_b16 v[210:211], v12 offset:2048
    ds_read_b64_tr_b16 v[212:213], v13 offset:0
    ds_read_b64_tr_b16 v[214:215], v13 offset:2048
    ds_read_b64_tr_b16 v[216:217], v10 offset:4096
    ds_read_b64_tr_b16 v[218:219], v10 offset:6144
    ds_read_b64_tr_b16 v[220:221], v11 offset:4096
    ds_read_b64_tr_b16 v[222:223], v11 offset:6144
    s_nop 7
    v_max3_f32 v18, v120, v121, v122
    v_max3_f32 v18, v18, v123, v124
    v_max3_f32 v18, v18, v125, v126
    v_max3_f32 v18, v18, v127, v128
    v_max3_f32 v18, v18, v129, v130
    v_max3_f32 v18, v18, v131, v132
    v_max3_f32 v18, v18, v133, v134
    v_max3_f32 v18, v18, v135, v136
    v_max3_f32 v18, v18, v137, v138
    v_max3_f32 v18, v18, v139, v140
    v_max3_f32 v18, v18, v141, v142
    v_max3_f32 v18, v18, v143, v144
    v_max3_f32 v18, v18, v145, v146
    v_max3_f32 v18, v18, v147, v148
    v_max3_f32 v18, v18, v149, v150
    v_max_f32 v18, v18, v151
    v_mov_b32 v19, v18
    s_nop 1
    v_permlane32_swap_b32 v18, v19
    v_max_f32 v18, v18, v19
    v_mul_f32 v18, s36, v18
    v_add_f32 v19, 0x41000000, v16
    v_cmp_gt_f32 vcc, v18, v19
    s_nop 4
    s_cbranch_vccz L_skip3
    v_max_f32 v18, v18, v16
    v_sub_f32 v19, v16, v18
    v_exp_f32 v19, v19
    v_mov_b32 v16, v18
    s_nop 0
    v_mul_f32 v17, v17, v19
    v_mul_f32 v56, v56, v19
    v_mul_f32 v57, v57, v19
    v_mul_f32 v58, v58, v19
    v_mul_f32 v59, v59, v19
    v_mul_f32 v60, v60, v19
    v_mul_f32 v61, v61, v19
    v_mul_f32 v62, v62, v19
    v_mul_f32 v63, v63, v19
    v_mul_f32 v64, v64, v19
    v_mul_f32 v65, v65, v19
    v_mul_f32 v66, v66, v19
    v_mul_f32 v67, v67, v19
    v_mul_f32 v68, v68, v19
    v_mul_f32 v69, v69, v19
    v_mul_f32 v70, v70, v19
    v_mul_f32 v71, v71, v19
    v_mul_f32 v72, v72, v19
    v_mul_f32 v73, v73, v19
    v_mul_f32 v74, v74, v19
    v_mul_f32 v75, v75, v19
    v_mul_f32 v76, v76, v19
    v_mul_f32 v77, v77, v19
    v_mul_f32 v78, v78, v19
    v_mul_f32 v79, v79, v19
    v_mul_f32 v80, v80, v19
    v_mul_f32 v81, v81, v19
    v_mul_f32 v82, v82, v19
    v_mul_f32 v83, v83, v19
    v_mul_f32 v84, v84, v19
    v_mul_f32 v85, v85, v19
    v_mul_f32 v86, v86, v19
    v_mul_f32 v87, v87, v19
    v_mul_f32 v88, v88, v19
    v_mul_f32 v89, v89, v19
    v_mul_f32 v90, v90, v19
    v_mul_f32 v91, v91, v19
    v_mul_f32 v92, v92, v19
    v_mul_f32 v93, v93, v19
    v_mul_f32 v94, v94, v19
    v_mul_f32 v95, v95, v19
    v_mul_f32 v96, v96, v19
    v_mul_f32 v97, v97, v19
    v_mul_f32 v98, v98, v19
    v_mul_f32 v99, v99, v19
    v_mul_f32 v100, v100, v19
    v_mul_f32 v101, v101, v19
    v_mul_f32 v102, v102, v19
    v_mul_f32 v103, v103, v19
    v_mul_f32 v104, v104, v19
    v_mul_f32 v105, v105, v19
    v_mul_f32 v106, v106, v19
    v_mul_f32 v107, v107, v19
    v_mul_f32 v108, v108, v19
    v_mul_f32 v109, v109, v19
    v_mul_f32 v110, v110, v19
    v_mul_f32 v111, v111, v19
    v_mul_f32 v112, v112, v19
    v_mul_f32 v113, v113, v19
    v_mul_f32 v114, v114, v19
    v_mul_f32 v115, v115, v19
    v_mul_f32 v116, v116, v19
    v_mul_f32 v117, v117, v19
    v_mul_f32 v118, v118, v19
    v_mul_f32 v119, v119, v19
L_skip3:
    v_fma_f32 v120, v120, s36, -v16
    v_fma_f32 v121, v121, s36, -v16
    v_fma_f32 v122, v122, s36, -v16
    v_fma_f32 v123, v123, s36, -v16
    v_fma_f32 v124, v124, s36, -v16
    v_fma_f32 v125, v125, s36, -v16
    v_fma_f32 v126, v126, s36, -v16
    v_fma_f32 v127, v127, s36, -v16
    v_fma_f32 v128, v128, s36, -v16
    v_fma_f32 v129, v129, s36, -v16
    v_fma_f32 v130, v130, s36, -v16
    v_fma_f32 v131, v131, s36, -v16
    v_fma_f32 v132, v132, s36, -v16
    v_fma_f32 v133, v133, s36, -v16
    v_fma_f32 v134, v134, s36, -v16
    v_fma_f32 v135, v135, s36, -v16
    v_fma_f32 v136, v136, s36, -v16
    v_fma_f32 v137, v137, s36, -v16
    v_fma_f32 v138, v138, s36, -v16
    v_fma_f32 v139, v139, s36, -v16
    v_fma_f32 v140, v140, s36, -v16
    v_fma_f32 v141, v141, s36, -v16
    v_fma_f32 v142, v142, s36, -v16
    v_fma_f32 v143, v143, s36, -v16
    v_fma_f32 v144, v144, s36, -v16
    v_fma_f32 v145, v145, s36, -v16
    v_fma_f32 v146, v146, s36, -v16
    v_fma_f32 v147, v147, s36, -v16
    v_fma_f32 v148, v148, s36, -v16
    v_fma_f32 v149, v149, s36, -v16
    v_fma_f32 v150, v150, s36, -v16
    v_fma_f32 v151, v151, s36, -v16
    v_exp_f32 v120, v120
    v_exp_f32 v121, v121
    v_exp_f32 v122, v122
    v_exp_f32 v123, v123
    v_exp_f32 v124, v124
    v_exp_f32 v125, v125
    v_exp_f32 v126, v126
    v_exp_f32 v127, v127
    v_exp_f32 v128, v128
    v_exp_f32 v129, v129
    v_exp_f32 v130, v130
    v_exp_f32 v131, v131
    v_exp_f32 v132, v132
    v_exp_f32 v133, v133
    v_exp_f32 v134, v134
    v_exp_f32 v135, v135
    v_exp_f32 v136, v136
    v_exp_f32 v137, v137
    v_exp_f32 v138, v138
    v_exp_f32 v139, v139
    v_exp_f32 v140, v140
    v_exp_f32 v141, v141
    v_exp_f32 v142, v142
    v_exp_f32 v143, v143
    v_exp_f32 v144, v144
    v_exp_f32 v145, v145
    v_exp_f32 v146, v146
    v_exp_f32 v147, v147
    v_exp_f32 v148, v148
    v_exp_f32 v149, v149
    v_exp_f32 v150, v150
    v_exp_f32 v151, v151
    s_nop 0
    v_cvt_pk_bf16_f32 v152, v120, v121
    v_cvt_pk_bf16_f32 v153, v122, v123
    v_cvt_pk_bf16_f32 v154, v124, v125
    v_cvt_pk_bf16_f32 v155, v126, v127
    v_cvt_pk_bf16_f32 v156, v128, v129
    v_cvt_pk_bf16_f32 v157, v130, v131
    v_cvt_pk_bf16_f32 v158, v132, v133
    v_cvt_pk_bf16_f32 v159, v134, v135
    v_cvt_pk_bf16_f32 v160, v136, v137
    v_cvt_pk_bf16_f32 v161, v138, v139
    v_cvt_pk_bf16_f32 v162, v140, v141
    v_cvt_pk_bf16_f32 v163, v142, v143
    v_cvt_pk_bf16_f32 v164, v144, v145
    v_cvt_pk_bf16_f32 v165, v146, v147
    v_cvt_pk_bf16_f32 v166, v148, v149
    v_cvt_pk_bf16_f32 v167, v150, v151
    v_add_f32 v20, v120, v121
    v_add_f32 v21, v122, v123
    v_add_f32 v20, v20, v124
    v_add_f32 v21, v21, v125
    v_add_f32 v20, v20, v126
    v_add_f32 v21, v21, v127
    v_add_f32 v20, v20, v128
    v_add_f32 v21, v21, v129
    v_add_f32 v20, v20, v130
    v_add_f32 v21, v21, v131
    v_add_f32 v20, v20, v132
    v_add_f32 v21, v21, v133
    v_add_f32 v20, v20, v134
    v_add_f32 v21, v21, v135
    v_add_f32 v20, v20, v136
    v_add_f32 v21, v21, v137
    v_add_f32 v20, v20, v138
    v_add_f32 v21, v21, v139
    v_add_f32 v20, v20, v140
    v_add_f32 v21, v21, v141
    v_add_f32 v20, v20, v142
    v_add_f32 v21, v21, v143
    v_add_f32 v20, v20, v144
    v_add_f32 v21, v21, v145
    v_add_f32 v20, v20, v146
    v_add_f32 v21, v21, v147
    v_add_f32 v20, v20, v148
    v_add_f32 v21, v21, v149
    v_add_f32 v20, v20, v150
    v_add_f32 v21, v21, v151
    v_add_f32 v17, v17, v20
    v_add_f32 v17, v17, v21
    s_waitcnt lgkmcnt(10)
    v_mfma_f32_32x32x16_bf16 v[56:71], v[200:203], v[152:155], v[56:71]
    ds_read_b64_tr_b16 v[224:225], v12 offset:4096
    ds_read_b64_tr_b16 v[226:227], v12 offset:6144
    s_waitcnt lgkmcnt(10)
    v_mfma_f32_32x32x16_bf16 v[72:87], v[204:207], v[152:155], v[72:87]
    ds_read_b64_tr_b16 v[228:229], v13 offset:4096
    ds_read_b64_tr_b16 v[230:231], v13 offset:6144
    s_waitcnt lgkmcnt(10)
    v_mfma_f32_32x32x16_bf16 v[88:103], v[208:211], v[152:155], v[88:103]
    ds_read_b64_tr_b16 v[200:201], v10 offset:8192
    ds_read_b64_tr_b16 v[202:203], v10 offset:10240
    s_waitcnt lgkmcnt(10)
    v_mfma_f32_32x32x16_bf16 v[104:119], v[212:215], v[152:155], v[104:119]
    ds_read_b64_tr_b16 v[204:205], v11 offset:8192
    ds_read_b64_tr_b16 v[206:207], v11 offset:10240
    s_waitcnt lgkmcnt(10)
    v_mfma_f32_32x32x16_bf16 v[56:71], v[216:219], v[156:159], v[56:71]
    ds_read_b64_tr_b16 v[208:209], v12 offset:8192
    ds_read_b64_tr_b16 v[210:211], v12 offset:10240
    s_waitcnt lgkmcnt(10)
    v_mfma_f32_32x32x16_bf16 v[72:87], v[220:223], v[156:159], v[72:87]
    ds_read_b64_tr_b16 v[212:213], v13 offset:8192
    ds_read_b64_tr_b16 v[214:215], v13 offset:10240
    s_waitcnt lgkmcnt(10)
    v_mfma_f32_32x32x16_bf16 v[88:103], v[224:227], v[156:159], v[88:103]
    ds_read_b64_tr_b16 v[216:217], v10 offset:12288
    ds_read_b64_tr_b16 v[218:219], v10 offset:14336
    s_waitcnt lgkmcnt(10)
    v_mfma_f32_32x32x16_bf16 v[104:119], v[228:231], v[156:159], v[104:119]
    ds_read_b64_tr_b16 v[220:221], v11 offset:12288
    ds_read_b64_tr_b16 v[222:223], v11 offset:14336
    s_waitcnt lgkmcnt(10)
    v_mfma_f32_32x32x16_bf16 v[56:71], v[200:203], v[160:163], v[56:71]
    ds_read_b64_tr_b16 v[224:225], v12 offset:12288
    ds_read_b64_tr_b16 v[226:227], v12 offset:14336
    s_waitcnt lgkmcnt(10)
    v_mfma_f32_32x32x16_bf16 v[72:87], v[204:207], v[160:163], v[72:87]
    ds_read_b64_tr_b16 v[228:229], v13 offset:12288
    ds_read_b64_tr_b16 v[230:231], v13 offset:14336
    s_waitcnt lgkmcnt(10)
    v_mfma_f32_32x32x16_bf16 v[88:103], v[208:211], v[160:163], v[88:103]
    s_waitcnt lgkmcnt(8)
    v_mfma_f32_32x32x16_bf16 v[104:119], v[212:215], v[160:163], v[104:119]
    s_waitcnt lgkmcnt(6)
    v_mfma_f32_32x32x16_bf16 v[56:71], v[216:219], v[164:167], v[56:71]
    s_waitcnt lgkmcnt(4)
    v_mfma_f32_32x32x16_bf16 v[72:87], v[220:223], v[164:167], v[72:87]
    s_waitcnt lgkmcnt(2)
    v_mfma_f32_32x32x16_bf16 v[88:103], v[224:227], v[164:167], v[88:103]
    s_waitcnt lgkmcnt(0)
    v_mfma_f32_32x32x16_bf16 v[104:119], v[228:231], v[164:167], v[104:119]
    s_mov_b32 s42, 65536
    s_cmp_eq_u32 s29, 0
    s_cselect_b32 s42, 65536, s42
    s_mov_b32 s43, 65536
    s_cmp_eq_u32 s29, 0
    s_cselect_b32 s43, 65536, s43
    v_add_u32 v2, s42, v2
    v_add_u32 v3, s42, v3
    v_add_u32 v4, s42, v4
    v_add_u32 v5, s42, v5
    v_add_u32 v6, s42, v6
    v_add_u32 v7, s42, v7
    v_add_u32 v8, s42, v8
    v_add_u32 v9, s42, v9
    v_add_u32 v10, s43, v10
    v_add_u32 v11, s43, v11
    v_add_u32 v12, s43, v12
    v_add_u32 v13, s43, v13
    s_waitcnt vmcnt(15)
    s_barrier
    s_add_u32 m0, s31, 32768
    s_add_u32 s35, s41, 196608
    s_and_b32 s35, s35, 0x3ffff
    buffer_load_dwordx4 v14, s[4:7], s35 offen nt lds
    s_add_u32 m0, s31, 40960
    s_add_u32 s35, s41, 204800
    s_and_b32 s35, s35, 0x3ffff
    buffer_load_dwordx4 v14, s[4:7], s35 offen nt lds
    s_add_u32 m0, s31, 49152
    s_add_u32 s35, s41, 212992
    s_and_b32 s35, s35, 0x3ffff
    buffer_load_dwordx4 v14, s[4:7], s35 offen nt lds
    s_add_u32 m0, s31, 57344
    s_add_u32 s35, s41, 221184
    s_and_b32 s35, s35, 0x3ffff
    buffer_load_dwordx4 v14, s[4:7], s35 offen nt lds
    ds_read_b128 v[168:171], v2 offset:0
    ds_read_b128 v[172:175], v3 offset:0
    ds_read_b128 v[176:179], v4 offset:0
    ds_read_b128 v[180:183], v5 offset:0
    ds_read_b128 v[184:187], v6 offset:0
    ds_read_b128 v[188:191], v7 offset:0
    ds_read_b128 v[192:195], v8 offset:0
    ds_read_b128 v[196:199], v9 offset:0
    s_waitcnt lgkmcnt(7)
    v_mfma_f32_32x32x16_bf16 v[120:135], v[168:171], v[24:27], 0
    ds_read_b128 v[168:171], v2 offset:8192
    s_waitcnt lgkmcnt(7)
    v_mfma_f32_32x32x16_bf16 v[120:135], v[172:175], v[28:31], v[120:135]
    ds_read_b128 v[172:175], v3 offset:8192
    s_waitcnt lgkmcnt(7)
    v_mfma_f32_32x32x16_bf16 v[120:135], v[176:179], v[32:35], v[120:135]
    ds_read_b128 v[176:179], v4 offset:8192
    s_waitcnt lgkmcnt(7)
    v_mfma_f32_32x32x16_bf16 v[120:135], v[180:183], v[36:39], v[120:135]
    ds_read_b128 v[180:183], v5 offset:8192
    s_waitcnt lgkmcnt(7)
    v_mfma_f32_32x32x16_bf16 v[120:135], v[184:187], v[40:43], v[120:135]
    ds_read_b128 v[184:187], v6 offset:8192
    s_waitcnt lgkmcnt(7)
    v_mfma_f32_32x32x16_bf16 v[120:135], v[188:191], v[44:47], v[120:135]
    ds_read_b128 v[188:191], v7 offset:8192
    s_waitcnt lgkmcnt(7)
    v_mfma_f32_32x32x16_bf16 v[120:135], v[192:195], v[48:51], v[120:135]
    ds_read_b128 v[192:195], v8 offset:8192
    s_waitcnt lgkmcnt(7)
    v_mfma_f32_32x32x16_bf16 v[120:135], v[196:199], v[52:55], v[120:135]
    ds_read_b128 v[196:199], v9 offset:8192
    s_waitcnt lgkmcnt(7)
    v_mfma_f32_32x32x16_bf16 v[136:151], v[168:171], v[24:27], 0
    s_waitcnt lgkmcnt(6)
    v_mfma_f32_32x32x16_bf16 v[136:151], v[172:175], v[28:31], v[136:151]
    s_waitcnt lgkmcnt(5)
    v_mfma_f32_32x32x16_bf16 v[136:151], v[176:179], v[32:35], v[136:151]
    s_waitcnt lgkmcnt(4)
    v_mfma_f32_32x32x16_bf16 v[136:151], v[180:183], v[36:39], v[136:151]
    s_waitcnt lgkmcnt(3)
    v_mfma_f32_32x32x16_bf16 v[136:151], v[184:187], v[40:43], v[136:151]
    s_waitcnt lgkmcnt(2)
    v_mfma_f32_32x32x16_bf16 v[136:151], v[188:191], v[44:47], v[136:151]
    s_waitcnt lgkmcnt(1)
    v_mfma_f32_32x32x16_bf16 v[136:151], v[192:195], v[48:51], v[136:151]
    s_waitcnt lgkmcnt(0)
    v_mfma_f32_32x32x16_bf16 v[136:151], v[196:199], v[52:55], v[136:151]
    s_waitcnt vmcnt(12)
    s_barrier
    s_add_u32 m0, s31, 65536
    s_add_u32 s35, s41, 196608
    s_and_b32 s35, s35, 0x3ffff
    buffer_load_dwordx4 v15, s[8:11], s35 offen nt lds
    s_add_u32 m0, s31, 73728
    s_add_u32 s35, s41, 204800
    s_and_b32 s35, s35, 0x3ffff
    buffer_load_dwordx4 v15, s[8:11], s35 offen nt lds
    s_add_u32 m0, s31, 81920
    s_add_u32 s35, s41, 212992
    s_and_b32 s35, s35, 0x3ffff
    buffer_load_dwordx4 v15, s[8:11], s35 offen nt lds
    s_add_u32 m0, s31, 90112
    s_add_u32 s35, s41, 221184
    s_and_b32 s35, s35, 0x3ffff
    buffer_load_dwordx4 v15, s[8:11], s35 offen nt lds
    ds_read_b64_tr_b16 v[200:201], v10 offset:0
    ds_read_b64_tr_b16 v[202:203], v10 offset:2048
    ds_read_b64_tr_b16 v[204:205], v11 offset:0
    ds_read_b64_tr_b16 v[206:207], v11 offset:2048
    ds_read_b64_tr_b16 v[208:209], v12 offset:0
    ds_read_b64_tr_b16 v[210:211], v12 offset:2048
    ds_read_b64_tr_b16 v[212:213], v13 offset:0
    ds_read_b64_tr_b16 v[214:215], v13 offset:2048
    ds_read_b64_tr_b16 v[216:217], v10 offset:4096
    ds_read_b64_tr_b16 v[218:219], v10 offset:6144
    ds_read_b64_tr_b16 v[220:221], v11 offset:4096
    ds_read_b64_tr_b16 v[222:223], v11 offset:6144
    s_nop 7
    v_max3_f32 v18, v120, v121, v122
    v_max3_f32 v18, v18, v123, v124
    v_max3_f32 v18, v18, v125, v126
    v_max3_f32 v18, v18, v127, v128
    v_max3_f32 v18, v18, v129, v130
    v_max3_f32 v18, v18, v131, v132
    v_max3_f32 v18, v18, v133, v134
    v_max3_f32 v18, v18, v135, v136
    v_max3_f32 v18, v18, v137, v138
    v_max3_f32 v18, v18, v139, v140
    v_max3_f32 v18, v18, v141, v142
    v_max3_f32 v18, v18, v143, v144
    v_max3_f32 v18, v18, v145, v146
    v_max3_f32 v18, v18, v147, v148
    v_max3_f32 v18, v18, v149, v150
    v_max_f32 v18, v18, v151
    v_mov_b32 v19, v18
    s_nop 1
    v_permlane32_swap_b32 v18, v19
    v_max_f32 v18, v18, v19
    v_mul_f32 v18, s36, v18
    v_add_f32 v19, 0x41000000, v16
    v_cmp_gt_f32 vcc, v18, v19
    s_nop 4
    s_cbranch_vccz L_skip4
    v_max_f32 v18, v18, v16
    v_sub_f32 v19, v16, v18
    v_exp_f32 v19, v19
    v_mov_b32 v16, v18
    s_nop 0
    v_mul_f32 v17, v17, v19
    v_mul_f32 v56, v56, v19
    v_mul_f32 v57, v57, v19
    v_mul_f32 v58, v58, v19
    v_mul_f32 v59, v59, v19
    v_mul_f32 v60, v60, v19
    v_mul_f32 v61, v61, v19
    v_mul_f32 v62, v62, v19
    v_mul_f32 v63, v63, v19
    v_mul_f32 v64, v64, v19
    v_mul_f32 v65, v65, v19
    v_mul_f32 v66, v66, v19
    v_mul_f32 v67, v67, v19
    v_mul_f32 v68, v68, v19
    v_mul_f32 v69, v69, v19
    v_mul_f32 v70, v70, v19
    v_mul_f32 v71, v71, v19
    v_mul_f32 v72, v72, v19
    v_mul_f32 v73, v73, v19
    v_mul_f32 v74, v74, v19
    v_mul_f32 v75, v75, v19
    v_mul_f32 v76, v76, v19
    v_mul_f32 v77, v77, v19
    v_mul_f32 v78, v78, v19
    v_mul_f32 v79, v79, v19
    v_mul_f32 v80, v80, v19
    v_mul_f32 v81, v81, v19
    v_mul_f32 v82, v82, v19
    v_mul_f32 v83, v83, v19
    v_mul_f32 v84, v84, v19
    v_mul_f32 v85, v85, v19
    v_mul_f32 v86, v86, v19
    v_mul_f32 v87, v87, v19
    v_mul_f32 v88, v88, v19
    v_mul_f32 v89, v89, v19
    v_mul_f32 v90, v90, v19
    v_mul_f32 v91, v91, v19
    v_mul_f32 v92, v92, v19
    v_mul_f32 v93, v93, v19
    v_mul_f32 v94, v94, v19
    v_mul_f32 v95, v95, v19
    v_mul_f32 v96, v96, v19
    v_mul_f32 v97, v97, v19
    v_mul_f32 v98, v98, v19
    v_mul_f32 v99, v99, v19
    v_mul_f32 v100, v100, v19
    v_mul_f32 v101, v101, v19
    v_mul_f32 v102, v102, v19
    v_mul_f32 v103, v103, v19
    v_mul_f32 v104, v104, v19
    v_mul_f32 v105, v105, v19
    v_mul_f32 v106, v106, v19
    v_mul_f32 v107, v107, v19
    v_mul_f32 v108, v108, v19
    v_mul_f32 v109, v109, v19
    v_mul_f32 v110, v110, v19
    v_mul_f32 v111, v111, v19
    v_mul_f32 v112, v112, v19
    v_mul_f32 v113, v113, v19
    v_mul_f32 v114, v114, v19
    v_mul_f32 v115, v115, v19
    v_mul_f32 v116, v116, v19
    v_mul_f32 v117, v117, v19
    v_mul_f32 v118, v118, v19
    v_mul_f32 v119, v119, v19
L_skip4:
    v_fma_f32 v120, v120, s36, -v16
    v_fma_f32 v121, v121, s36, -v16
    v_fma_f32 v122, v122, s36, -v16
    v_fma_f32 v123, v123, s36, -v16
    v_fma_f32 v124, v124, s36, -v16
    v_fma_f32 v125, v125, s36, -v16
    v_fma_f32 v126, v126, s36, -v16
    v_fma_f32 v127, v127, s36, -v16
    v_fma_f32 v128, v128, s36, -v16
    v_fma_f32 v129, v129, s36, -v16
    v_fma_f32 v130, v130, s36, -v16
    v_fma_f32 v131, v131, s36, -v16
    v_fma_f32 v132, v132, s36, -v16
    v_fma_f32 v133, v133, s36, -v16
    v_fma_f32 v134, v134, s36, -v16
    v_fma_f32 v135, v135, s36, -v16
    v_fma_f32 v136, v136, s36, -v16
    v_fma_f32 v137, v137, s36, -v16
    v_fma_f32 v138, v138, s36, -v16
    v_fma_f32 v139, v139, s36, -v16
    v_fma_f32 v140, v140, s36, -v16
    v_fma_f32 v141, v141, s36, -v16
    v_fma_f32 v142, v142, s36, -v16
    v_fma_f32 v143, v143, s36, -v16
    v_fma_f32 v144, v144, s36, -v16
    v_fma_f32 v145, v145, s36, -v16
    v_fma_f32 v146, v146, s36, -v16
    v_fma_f32 v147, v147, s36, -v16
    v_fma_f32 v148, v148, s36, -v16
    v_fma_f32 v149, v149, s36, -v16
    v_fma_f32 v150, v150, s36, -v16
    v_fma_f32 v151, v151, s36, -v16
    v_exp_f32 v120, v120
    v_exp_f32 v121, v121
    v_exp_f32 v122, v122
    v_exp_f32 v123, v123
    v_exp_f32 v124, v124
    v_exp_f32 v125, v125
    v_exp_f32 v126, v126
    v_exp_f32 v127, v127
    v_exp_f32 v128, v128
    v_exp_f32 v129, v129
    v_exp_f32 v130, v130
    v_exp_f32 v131, v131
    v_exp_f32 v132, v132
    v_exp_f32 v133, v133
    v_exp_f32 v134, v134
    v_exp_f32 v135, v135
    v_exp_f32 v136, v136
    v_exp_f32 v137, v137
    v_exp_f32 v138, v138
    v_exp_f32 v139, v139
    v_exp_f32 v140, v140
    v_exp_f32 v141, v141
    v_exp_f32 v142, v142
    v_exp_f32 v143, v143
    v_exp_f32 v144, v144
    v_exp_f32 v145, v145
    v_exp_f32 v146, v146
    v_exp_f32 v147, v147
    v_exp_f32 v148, v148
    v_exp_f32 v149, v149
    v_exp_f32 v150, v150
    v_exp_f32 v151, v151
    s_nop 0
    v_cvt_pk_bf16_f32 v152, v120, v121
    v_cvt_pk_bf16_f32 v153, v122, v123
    v_cvt_pk_bf16_f32 v154, v124, v125
    v_cvt_pk_bf16_f32 v155, v126, v127
    v_cvt_pk_bf16_f32 v156, v128, v129
    v_cvt_pk_bf16_f32 v157, v130, v131
    v_cvt_pk_bf16_f32 v158, v132, v133
    v_cvt_pk_bf16_f32 v159, v134, v135
    v_cvt_pk_bf16_f32 v160, v136, v137
    v_cvt_pk_bf16_f32 v161, v138, v139
    v_cvt_pk_bf16_f32 v162, v140, v141
    v_cvt_pk_bf16_f32 v163, v142, v143
    v_cvt_pk_bf16_f32 v164, v144, v145
    v_cvt_pk_bf16_f32 v165, v146, v147
    v_cvt_pk_bf16_f32 v166, v148, v149
    v_cvt_pk_bf16_f32 v167, v150, v151
    v_add_f32 v20, v120, v121
    v_add_f32 v21, v122, v123
    v_add_f32 v20, v20, v124
    v_add_f32 v21, v21, v125
    v_add_f32 v20, v20, v126
    v_add_f32 v21, v21, v127
    v_add_f32 v20, v20, v128
    v_add_f32 v21, v21, v129
    v_add_f32 v20, v20, v130
    v_add_f32 v21, v21, v131
    v_add_f32 v20, v20, v132
    v_add_f32 v21, v21, v133
    v_add_f32 v20, v20, v134
    v_add_f32 v21, v21, v135
    v_add_f32 v20, v20, v136
    v_add_f32 v21, v21, v137
    v_add_f32 v20, v20, v138
    v_add_f32 v21, v21, v139
    v_add_f32 v20, v20, v140
    v_add_f32 v21, v21, v141
    v_add_f32 v20, v20, v142
    v_add_f32 v21, v21, v143
    v_add_f32 v20, v20, v144
    v_add_f32 v21, v21, v145
    v_add_f32 v20, v20, v146
    v_add_f32 v21, v21, v147
    v_add_f32 v20, v20, v148
    v_add_f32 v21, v21, v149
    v_add_f32 v20, v20, v150
    v_add_f32 v21, v21, v151
    v_add_f32 v17, v17, v20
    v_add_f32 v17, v17, v21
    s_waitcnt lgkmcnt(10)
    v_mfma_f32_32x32x16_bf16 v[56:71], v[200:203], v[152:155], v[56:71]
    ds_read_b64_tr_b16 v[224:225], v12 offset:4096
    ds_read_b64_tr_b16 v[226:227], v12 offset:6144
    s_waitcnt lgkmcnt(10)
    v_mfma_f32_32x32x16_bf16 v[72:87], v[204:207], v[152:155], v[72:87]
    ds_read_b64_tr_b16 v[228:229], v13 offset:4096
    ds_read_b64_tr_b16 v[230:231], v13 offset:6144
    s_waitcnt lgkmcnt(10)
    v_mfma_f32_32x32x16_bf16 v[88:103], v[208:211], v[152:155], v[88:103]
    ds_read_b64_tr_b16 v[200:201], v10 offset:8192
    ds_read_b64_tr_b16 v[202:203], v10 offset:10240
    s_waitcnt lgkmcnt(10)
    v_mfma_f32_32x32x16_bf16 v[104:119], v[212:215], v[152:155], v[104:119]
    ds_read_b64_tr_b16 v[204:205], v11 offset:8192
    ds_read_b64_tr_b16 v[206:207], v11 offset:10240
    s_waitcnt lgkmcnt(10)
    v_mfma_f32_32x32x16_bf16 v[56:71], v[216:219], v[156:159], v[56:71]
    ds_read_b64_tr_b16 v[208:209], v12 offset:8192
    ds_read_b64_tr_b16 v[210:211], v12 offset:10240
    s_waitcnt lgkmcnt(10)
    v_mfma_f32_32x32x16_bf16 v[72:87], v[220:223], v[156:159], v[72:87]
    ds_read_b64_tr_b16 v[212:213], v13 offset:8192
    ds_read_b64_tr_b16 v[214:215], v13 offset:10240
    s_waitcnt lgkmcnt(10)
    v_mfma_f32_32x32x16_bf16 v[88:103], v[224:227], v[156:159], v[88:103]
    ds_read_b64_tr_b16 v[216:217], v10 offset:12288
    ds_read_b64_tr_b16 v[218:219], v10 offset:14336
    s_waitcnt lgkmcnt(10)
    v_mfma_f32_32x32x16_bf16 v[104:119], v[228:231], v[156:159], v[104:119]
    ds_read_b64_tr_b16 v[220:221], v11 offset:12288
    ds_read_b64_tr_b16 v[222:223], v11 offset:14336
    s_waitcnt lgkmcnt(10)
    v_mfma_f32_32x32x16_bf16 v[56:71], v[200:203], v[160:163], v[56:71]
    ds_read_b64_tr_b16 v[224:225], v12 offset:12288
    ds_read_b64_tr_b16 v[226:227], v12 offset:14336
    s_waitcnt lgkmcnt(10)
    v_mfma_f32_32x32x16_bf16 v[72:87], v[204:207], v[160:163], v[72:87]
    ds_read_b64_tr_b16 v[228:229], v13 offset:12288
    ds_read_b64_tr_b16 v[230:231], v13 offset:14336
    s_waitcnt lgkmcnt(10)
    v_mfma_f32_32x32x16_bf16 v[88:103], v[208:211], v[160:163], v[88:103]
    s_waitcnt lgkmcnt(8)
    v_mfma_f32_32x32x16_bf16 v[104:119], v[212:215], v[160:163], v[104:119]
    s_waitcnt lgkmcnt(6)
    v_mfma_f32_32x32x16_bf16 v[56:71], v[216:219], v[164:167], v[56:71]
    s_waitcnt lgkmcnt(4)
    v_mfma_f32_32x32x16_bf16 v[72:87], v[220:223], v[164:167], v[72:87]
    s_waitcnt lgkmcnt(2)
    v_mfma_f32_32x32x16_bf16 v[88:103], v[224:227], v[164:167], v[88:103]
    s_waitcnt lgkmcnt(0)
    v_mfma_f32_32x32x16_bf16 v[104:119], v[228:231], v[164:167], v[104:119]
    s_mov_b32 s42, 65536
    s_cmp_eq_u32 s29, 0
    s_cselect_b32 s42, 65536, s42
    s_mov_b32 s43, -98304
    s_cmp_eq_u32 s29, 0
    s_cselect_b32 s43, -98304, s43
    v_add_u32 v2, s42, v2
    v_add_u32 v3, s42, v3
    v_add_u32 v4, s42, v4
    v_add_u32 v5, s42, v5
    v_add_u32 v6, s42, v6
    v_add_u32 v7, s42, v7
    v_add_u32 v8, s42, v8
    v_add_u32 v9, s42, v9
    v_add_u32 v10, s43, v10
    v_add_u32 v11, s43, v11
    v_add_u32 v12, s43, v12
    v_add_u32 v13, s43, v13
    s_waitcnt vmcnt(12)
    s_barrier
    s_add_u32 m0, s31, 98304
    s_add_u32 s35, s41, 229376
    s_and_b32 s35, s35, 0x3ffff
    buffer_load_dwordx4 v14, s[4:7], s35 offen nt lds
    s_add_u32 m0, s31, 106496
    s_add_u32 s35, s41, 237568
    s_and_b32 s35, s35, 0x3ffff
    buffer_load_dwordx4 v14, s[4:7], s35 offen nt lds
    s_add_u32 m0, s31, 114688
    s_add_u32 s35, s41, 245760
    s_and_b32 s35, s35, 0x3ffff
    buffer_load_dwordx4 v14, s[4:7], s35 offen nt lds
    s_add_u32 m0, s31, 122880
    s_add_u32 s35, s41, 253952
    s_and_b32 s35, s35, 0x3ffff
    buffer_load_dwordx4 v14, s[4:7], s35 offen nt lds
    ds_read_b128 v[168:171], v2 offset:0
    ds_read_b128 v[172:175], v3 offset:0
    ds_read_b128 v[176:179], v4 offset:0
    ds_read_b128 v[180:183], v5 offset:0
    ds_read_b128 v[184:187], v6 offset:0
    ds_read_b128 v[188:191], v7 offset:0
    ds_read_b128 v[192:195], v8 offset:0
    ds_read_b128 v[196:199], v9 offset:0
    s_waitcnt lgkmcnt(7)
    v_mfma_f32_32x32x16_bf16 v[120:135], v[168:171], v[24:27], 0
    ds_read_b128 v[168:171], v2 offset:8192
    s_waitcnt lgkmcnt(7)
    v_mfma_f32_32x32x16_bf16 v[120:135], v[172:175], v[28:31], v[120:135]
    ds_read_b128 v[172:175], v3 offset:8192
    s_waitcnt lgkmcnt(7)
    v_mfma_f32_32x32x16_bf16 v[120:135], v[176:179], v[32:35], v[120:135]
    ds_read_b128 v[176:179], v4 offset:8192
    s_waitcnt lgkmcnt(7)
    v_mfma_f32_32x32x16_bf16 v[120:135], v[180:183], v[36:39], v[120:135]
    ds_read_b128 v[180:183], v5 offset:8192
    s_waitcnt lgkmcnt(7)
    v_mfma_f32_32x32x16_bf16 v[120:135], v[184:187], v[40:43], v[120:135]
    ds_read_b128 v[184:187], v6 offset:8192
    s_waitcnt lgkmcnt(7)
    v_mfma_f32_32x32x16_bf16 v[120:135], v[188:191], v[44:47], v[120:135]
    ds_read_b128 v[188:191], v7 offset:8192
    s_waitcnt lgkmcnt(7)
    v_mfma_f32_32x32x16_bf16 v[120:135], v[192:195], v[48:51], v[120:135]
    ds_read_b128 v[192:195], v8 offset:8192
    s_waitcnt lgkmcnt(7)
    v_mfma_f32_32x32x16_bf16 v[120:135], v[196:199], v[52:55], v[120:135]
    ds_read_b128 v[196:199], v9 offset:8192
    s_waitcnt lgkmcnt(7)
    v_mfma_f32_32x32x16_bf16 v[136:151], v[168:171], v[24:27], 0
    s_waitcnt lgkmcnt(6)
    v_mfma_f32_32x32x16_bf16 v[136:151], v[172:175], v[28:31], v[136:151]
    s_waitcnt lgkmcnt(5)
    v_mfma_f32_32x32x16_bf16 v[136:151], v[176:179], v[32:35], v[136:151]
    s_waitcnt lgkmcnt(4)
    v_mfma_f32_32x32x16_bf16 v[136:151], v[180:183], v[36:39], v[136:151]
    s_waitcnt lgkmcnt(3)
    v_mfma_f32_32x32x16_bf16 v[136:151], v[184:187], v[40:43], v[136:151]
    s_waitcnt lgkmcnt(2)
    v_mfma_f32_32x32x16_bf16 v[136:151], v[188:191], v[44:47], v[136:151]
    s_waitcnt lgkmcnt(1)
    v_mfma_f32_32x32x16_bf16 v[136:151], v[192:195], v[48:51], v[136:151]
    s_waitcnt lgkmcnt(0)
    v_mfma_f32_32x32x16_bf16 v[136:151], v[196:199], v[52:55], v[136:151]
    s_waitcnt vmcnt(12)
    s_barrier
    s_add_u32 m0, s31, 131072
    s_add_u32 s35, s41, 229376
    s_and_b32 s35, s35, 0x3ffff
    buffer_load_dwordx4 v15, s[8:11], s35 offen nt lds
    s_add_u32 m0, s31, 139264
    s_add_u32 s35, s41, 237568
    s_and_b32 s35, s35, 0x3ffff
    buffer_load_dwordx4 v15, s[8:11], s35 offen nt lds
    s_add_u32 m0, s31, 147456
    s_add_u32 s35, s41, 245760
    s_and_b32 s35, s35, 0x3ffff
    buffer_load_dwordx4 v15, s[8:11], s35 offen nt lds
    s_add_u32 m0, s31, 155648
    s_add_u32 s35, s41, 253952
    s_and_b32 s35, s35, 0x3ffff
    buffer_load_dwordx4 v15, s[8:11], s35 offen nt lds
    ds_read_b64_tr_b16 v[200:201], v10 offset:0
    ds_read_b64_tr_b16 v[202:203], v10 offset:2048
    ds_read_b64_tr_b16 v[204:205], v11 offset:0
    ds_read_b64_tr_b16 v[206:207], v11 offset:2048
    ds_read_b64_tr_b16 v[208:209], v12 offset:0
    ds_read_b64_tr_b16 v[210:211], v12 offset:2048
    ds_read_b64_tr_b16 v[212:213], v13 offset:0
    ds_read_b64_tr_b16 v[214:215], v13 offset:2048
    ds_read_b64_tr_b16 v[216:217], v10 offset:4096
    ds_read_b64_tr_b16 v[218:219], v10 offset:6144
    ds_read_b64_tr_b16 v[220:221], v11 offset:4096
    ds_read_b64_tr_b16 v[222:223], v11 offset:6144
    s_nop 7
    v_max3_f32 v18, v120, v121, v122
    v_max3_f32 v18, v18, v123, v124
    v_max3_f32 v18, v18, v125, v126
    v_max3_f32 v18, v18, v127, v128
    v_max3_f32 v18, v18, v129, v130
    v_max3_f32 v18, v18, v131, v132
    v_max3_f32 v18, v18, v133, v134
    v_max3_f32 v18, v18, v135, v136
    v_max3_f32 v18, v18, v137, v138
    v_max3_f32 v18, v18, v139, v140
    v_max3_f32 v18, v18, v141, v142
    v_max3_f32 v18, v18, v143, v144
    v_max3_f32 v18, v18, v145, v146
    v_max3_f32 v18, v18, v147, v148
    v_max3_f32 v18, v18, v149, v150
    v_max_f32 v18, v18, v151
    v_mov_b32 v19, v18
    s_nop 1
    v_permlane32_swap_b32 v18, v19
    v_max_f32 v18, v18, v19
    v_mul_f32 v18, s36, v18
    v_add_f32 v19, 0x41000000, v16
    v_cmp_gt_f32 vcc, v18, v19
    s_nop 4
    s_cbranch_vccz L_skip5
    v_max_f32 v18, v18, v16
    v_sub_f32 v19, v16, v18
    v_exp_f32 v19, v19
    v_mov_b32 v16, v18
    s_nop 0
    v_mul_f32 v17, v17, v19
    v_mul_f32 v56, v56, v19
    v_mul_f32 v57, v57, v19
    v_mul_f32 v58, v58, v19
    v_mul_f32 v59, v59, v19
    v_mul_f32 v60, v60, v19
    v_mul_f32 v61, v61, v19
    v_mul_f32 v62, v62, v19
    v_mul_f32 v63, v63, v19
    v_mul_f32 v64, v64, v19
    v_mul_f32 v65, v65, v19
    v_mul_f32 v66, v66, v19
    v_mul_f32 v67, v67, v19
    v_mul_f32 v68, v68, v19
    v_mul_f32 v69, v69, v19
    v_mul_f32 v70, v70, v19
    v_mul_f32 v71, v71, v19
    v_mul_f32 v72, v72, v19
    v_mul_f32 v73, v73, v19
    v_mul_f32 v74, v74, v19
    v_mul_f32 v75, v75, v19
    v_mul_f32 v76, v76, v19
    v_mul_f32 v77, v77, v19
    v_mul_f32 v78, v78, v19
    v_mul_f32 v79, v79, v19
    v_mul_f32 v80, v80, v19
    v_mul_f32 v81, v81, v19
    v_mul_f32 v82, v82, v19
    v_mul_f32 v83, v83, v19
    v_mul_f32 v84, v84, v19
    v_mul_f32 v85, v85, v19
    v_mul_f32 v86, v86, v19
    v_mul_f32 v87, v87, v19
    v_mul_f32 v88, v88, v19
    v_mul_f32 v89, v89, v19
    v_mul_f32 v90, v90, v19
    v_mul_f32 v91, v91, v19
    v_mul_f32 v92, v92, v19
    v_mul_f32 v93, v93, v19
    v_mul_f32 v94, v94, v19
    v_mul_f32 v95, v95, v19
    v_mul_f32 v96, v96, v19
    v_mul_f32 v97, v97, v19
    v_mul_f32 v98, v98, v19
    v_mul_f32 v99, v99, v19
    v_mul_f32 v100, v100, v19
    v_mul_f32 v101, v101, v19
    v_mul_f32 v102, v102, v19
    v_mul_f32 v103, v103, v19
    v_mul_f32 v104, v104, v19
    v_mul_f32 v105, v105, v19
    v_mul_f32 v106, v106, v19
    v_mul_f32 v107, v107, v19
    v_mul_f32 v108, v108, v19
    v_mul_f32 v109, v109, v19
    v_mul_f32 v110, v110, v19
    v_mul_f32 v111, v111, v19
    v_mul_f32 v112, v112, v19
    v_mul_f32 v113, v113, v19
    v_mul_f32 v114, v114, v19
    v_mul_f32 v115, v115, v19
    v_mul_f32 v116, v116, v19
    v_mul_f32 v117, v117, v19
    v_mul_f32 v118, v118, v19
    v_mul_f32 v119, v119, v19
L_skip5:
    v_fma_f32 v120, v120, s36, -v16
    v_fma_f32 v121, v121, s36, -v16
    v_fma_f32 v122, v122, s36, -v16
    v_fma_f32 v123, v123, s36, -v16
    v_fma_f32 v124, v124, s36, -v16
    v_fma_f32 v125, v125, s36, -v16
    v_fma_f32 v126, v126, s36, -v16
    v_fma_f32 v127, v127, s36, -v16
    v_fma_f32 v128, v128, s36, -v16
    v_fma_f32 v129, v129, s36, -v16
    v_fma_f32 v130, v130, s36, -v16
    v_fma_f32 v131, v131, s36, -v16
    v_fma_f32 v132, v132, s36, -v16
    v_fma_f32 v133, v133, s36, -v16
    v_fma_f32 v134, v134, s36, -v16
    v_fma_f32 v135, v135, s36, -v16
    v_fma_f32 v136, v136, s36, -v16
    v_fma_f32 v137, v137, s36, -v16
    v_fma_f32 v138, v138, s36, -v16
    v_fma_f32 v139, v139, s36, -v16
    v_fma_f32 v140, v140, s36, -v16
    v_fma_f32 v141, v141, s36, -v16
    v_fma_f32 v142, v142, s36, -v16
    v_fma_f32 v143, v143, s36, -v16
    v_fma_f32 v144, v144, s36, -v16
    v_fma_f32 v145, v145, s36, -v16
    v_fma_f32 v146, v146, s36, -v16
    v_fma_f32 v147, v147, s36, -v16
    v_fma_f32 v148, v148, s36, -v16
    v_fma_f32 v149, v149, s36, -v16
    v_fma_f32 v150, v150, s36, -v16
    v_fma_f32 v151, v151, s36, -v16
    v_exp_f32 v120, v120
    v_exp_f32 v121, v121
    v_exp_f32 v122, v122
    v_exp_f32 v123, v123
    v_exp_f32 v124, v124
    v_exp_f32 v125, v125
    v_exp_f32 v126, v126
    v_exp_f32 v127, v127
    v_exp_f32 v128, v128
    v_exp_f32 v129, v129
    v_exp_f32 v130, v130
    v_exp_f32 v131, v131
    v_exp_f32 v132, v132
    v_exp_f32 v133, v133
    v_exp_f32 v134, v134
    v_exp_f32 v135, v135
    v_exp_f32 v136, v136
    v_exp_f32 v137, v137
    v_exp_f32 v138, v138
    v_exp_f32 v139, v139
    v_exp_f32 v140, v140
    v_exp_f32 v141, v141
    v_exp_f32 v142, v142
    v_exp_f32 v143, v143
    v_exp_f32 v144, v144
    v_exp_f32 v145, v145
    v_exp_f32 v146, v146
    v_exp_f32 v147, v147
    v_exp_f32 v148, v148
    v_exp_f32 v149, v149
    v_exp_f32 v150, v150
    v_exp_f32 v151, v151
    s_nop 0
    v_cvt_pk_bf16_f32 v152, v120, v121
    v_cvt_pk_bf16_f32 v153, v122, v123
    v_cvt_pk_bf16_f32 v154, v124, v125
    v_cvt_pk_bf16_f32 v155, v126, v127
    v_cvt_pk_bf16_f32 v156, v128, v129
    v_cvt_pk_bf16_f32 v157, v130, v131
    v_cvt_pk_bf16_f32 v158, v132, v133
    v_cvt_pk_bf16_f32 v159, v134, v135
    v_cvt_pk_bf16_f32 v160, v136, v137
    v_cvt_pk_bf16_f32 v161, v138, v139
    v_cvt_pk_bf16_f32 v162, v140, v141
    v_cvt_pk_bf16_f32 v163, v142, v143
    v_cvt_pk_bf16_f32 v164, v144, v145
    v_cvt_pk_bf16_f32 v165, v146, v147
    v_cvt_pk_bf16_f32 v166, v148, v149
    v_cvt_pk_bf16_f32 v167, v150, v151
    v_add_f32 v20, v120, v121
    v_add_f32 v21, v122, v123
    v_add_f32 v20, v20, v124
    v_add_f32 v21, v21, v125
    v_add_f32 v20, v20, v126
    v_add_f32 v21, v21, v127
    v_add_f32 v20, v20, v128
    v_add_f32 v21, v21, v129
    v_add_f32 v20, v20, v130
    v_add_f32 v21, v21, v131
    v_add_f32 v20, v20, v132
    v_add_f32 v21, v21, v133
    v_add_f32 v20, v20, v134
    v_add_f32 v21, v21, v135
    v_add_f32 v20, v20, v136
    v_add_f32 v21, v21, v137
    v_add_f32 v20, v20, v138
    v_add_f32 v21, v21, v139
    v_add_f32 v20, v20, v140
    v_add_f32 v21, v21, v141
    v_add_f32 v20, v20, v142
    v_add_f32 v21, v21, v143
    v_add_f32 v20, v20, v144
    v_add_f32 v21, v21, v145
    v_add_f32 v20, v20, v146
    v_add_f32 v21, v21, v147
    v_add_f32 v20, v20, v148
    v_add_f32 v21, v21, v149
    v_add_f32 v20, v20, v150
    v_add_f32 v21, v21, v151
    v_add_f32 v17, v17, v20
    v_add_f32 v17, v17, v21
    s_waitcnt lgkmcnt(10)
    v_mfma_f32_32x32x16_bf16 v[56:71], v[200:203], v[152:155], v[56:71]
    ds_read_b64_tr_b16 v[224:225], v12 offset:4096
    ds_read_b64_tr_b16 v[226:227], v12 offset:6144
    s_waitcnt lgkmcnt(10)
    v_mfma_f32_32x32x16_bf16 v[72:87], v[204:207], v[152:155], v[72:87]
    ds_read_b64_tr_b16 v[228:229], v13 offset:4096
    ds_read_b64_tr_b16 v[230:231], v13 offset:6144
    s_waitcnt lgkmcnt(10)
    v_mfma_f32_32x32x16_bf16 v[88:103], v[208:211], v[152:155], v[88:103]
    ds_read_b64_tr_b16 v[200:201], v10 offset:8192
    ds_read_b64_tr_b16 v[202:203], v10 offset:10240
    s_waitcnt lgkmcnt(10)
    v_mfma_f32_32x32x16_bf16 v[104:119], v[212:215], v[152:155], v[104:119]
    ds_read_b64_tr_b16 v[204:205], v11 offset:8192
    ds_read_b64_tr_b16 v[206:207], v11 offset:10240
    s_waitcnt lgkmcnt(10)
    v_mfma_f32_32x32x16_bf16 v[56:71], v[216:219], v[156:159], v[56:71]
    ds_read_b64_tr_b16 v[208:209], v12 offset:8192
    ds_read_b64_tr_b16 v[210:211], v12 offset:10240
    s_waitcnt lgkmcnt(10)
    v_mfma_f32_32x32x16_bf16 v[72:87], v[220:223], v[156:159], v[72:87]
    ds_read_b64_tr_b16 v[212:213], v13 offset:8192
    ds_read_b64_tr_b16 v[214:215], v13 offset:10240
    s_waitcnt lgkmcnt(10)
    v_mfma_f32_32x32x16_bf16 v[88:103], v[224:227], v[156:159], v[88:103]
    ds_read_b64_tr_b16 v[216:217], v10 offset:12288
    ds_read_b64_tr_b16 v[218:219], v10 offset:14336
    s_waitcnt lgkmcnt(10)
    v_mfma_f32_32x32x16_bf16 v[104:119], v[228:231], v[156:159], v[104:119]
    ds_read_b64_tr_b16 v[220:221], v11 offset:12288
    ds_read_b64_tr_b16 v[222:223], v11 offset:14336
    s_waitcnt lgkmcnt(10)
    v_mfma_f32_32x32x16_bf16 v[56:71], v[200:203], v[160:163], v[56:71]
    ds_read_b64_tr_b16 v[224:225], v12 offset:12288
    ds_read_b64_tr_b16 v[226:227], v12 offset:14336
    s_waitcnt lgkmcnt(10)
    v_mfma_f32_32x32x16_bf16 v[72:87], v[204:207], v[160:163], v[72:87]
    ds_read_b64_tr_b16 v[228:229], v13 offset:12288
    ds_read_b64_tr_b16 v[230:231], v13 offset:14336
    s_waitcnt lgkmcnt(10)
    v_mfma_f32_32x32x16_bf16 v[88:103], v[208:211], v[160:163], v[88:103]
    s_waitcnt lgkmcnt(8)
    v_mfma_f32_32x32x16_bf16 v[104:119], v[212:215], v[160:163], v[104:119]
    s_waitcnt lgkmcnt(6)
    v_mfma_f32_32x32x16_bf16 v[56:71], v[216:219], v[164:167], v[56:71]
    s_waitcnt lgkmcnt(4)
    v_mfma_f32_32x32x16_bf16 v[72:87], v[220:223], v[164:167], v[72:87]
    s_waitcnt lgkmcnt(2)
    v_mfma_f32_32x32x16_bf16 v[88:103], v[224:227], v[164:167], v[88:103]
    s_waitcnt lgkmcnt(0)
    v_mfma_f32_32x32x16_bf16 v[104:119], v[228:231], v[164:167], v[104:119]
    s_mov_b32 s42, -98304
    s_cmp_eq_u32 s29, 0
    s_cselect_b32 s42, -98304, s42
    s_mov_b32 s43, 65536
    s_cmp_eq_u32 s29, 0
    s_cselect_b32 s43, 65536, s43
    v_add_u32 v2, s42, v2
    v_add_u32 v3, s42, v3
    v_add_u32 v4, s42, v4
    v_add_u32 v5, s42, v5
    v_add_u32 v6, s42, v6
    v_add_u32 v7, s42, v7
    v_add_u32 v8, s42, v8
    v_add_u32 v9, s42, v9
    v_add_u32 v10, s43, v10
    v_add_u32 v11, s43, v11
    v_add_u32 v12, s43, v12
    v_add_u32 v13, s43, v13
    s_waitcnt vmcnt(12)
    s_barrier
    ds_read_b128 v[168:171], v2 offset:0
    ds_read_b128 v[172:175], v3 offset:0
    ds_read_b128 v[176:179], v4 offset:0
    ds_read_b128 v[180:183], v5 offset:0
    ds_read_b128 v[184:187], v6 offset:0
    ds_read_b128 v[188:191], v7 offset:0
    ds_read_b128 v[192:195], v8 offset:0
    ds_read_b128 v[196:199], v9 offset:0
    s_waitcnt lgkmcnt(7)
    v_mfma_f32_32x32x16_bf16 v[120:135], v[168:171], v[24:27], 0
    ds_read_b128 v[168:171], v2 offset:8192
    s_waitcnt lgkmcnt(7)
    v_mfma_f32_32x32x16_bf16 v[120:135], v[172:175], v[28:31], v[120:135]
    ds_read_b128 v[172:175], v3 offset:8192
    s_waitcnt lgkmcnt(7)
    v_mfma_f32_32x32x16_bf16 v[120:135], v[176:179], v[32:35], v[120:135]
    ds_read_b128 v[176:179], v4 offset:8192
    s_waitcnt lgkmcnt(7)
    v_mfma_f32_32x32x16_bf16 v[120:135], v[180:183], v[36:39], v[120:135]
    ds_read_b128 v[180:183], v5 offset:8192
    s_waitcnt lgkmcnt(7)
    v_mfma_f32_32x32x16_bf16 v[120:135], v[184:187], v[40:43], v[120:135]
    ds_read_b128 v[184:187], v6 offset:8192
    s_waitcnt lgkmcnt(7)
    v_mfma_f32_32x32x16_bf16 v[120:135], v[188:191], v[44:47], v[120:135]
    ds_read_b128 v[188:191], v7 offset:8192
    s_waitcnt lgkmcnt(7)
    v_mfma_f32_32x32x16_bf16 v[120:135], v[192:195], v[48:51], v[120:135]
    ds_read_b128 v[192:195], v8 offset:8192
    s_waitcnt lgkmcnt(7)
    v_mfma_f32_32x32x16_bf16 v[120:135], v[196:199], v[52:55], v[120:135]
    ds_read_b128 v[196:199], v9 offset:8192
    s_waitcnt lgkmcnt(7)
    v_mfma_f32_32x32x16_bf16 v[136:151], v[168:171], v[24:27], 0
    s_waitcnt lgkmcnt(6)
    v_mfma_f32_32x32x16_bf16 v[136:151], v[172:175], v[28:31], v[136:151]
    s_waitcnt lgkmcnt(5)
    v_mfma_f32_32x32x16_bf16 v[136:151], v[176:179], v[32:35], v[136:151]
    s_waitcnt lgkmcnt(4)
    v_mfma_f32_32x32x16_bf16 v[136:151], v[180:183], v[36:39], v[136:151]
    s_waitcnt lgkmcnt(3)
    v_mfma_f32_32x32x16_bf16 v[136:151], v[184:187], v[40:43], v[136:151]
    s_waitcnt lgkmcnt(2)
    v_mfma_f32_32x32x16_bf16 v[136:151], v[188:191], v[44:47], v[136:151]
    s_waitcnt lgkmcnt(1)
    v_mfma_f32_32x32x16_bf16 v[136:151], v[192:195], v[48:51], v[136:151]
    s_waitcnt lgkmcnt(0)
    v_mfma_f32_32x32x16_bf16 v[136:151], v[196:199], v[52:55], v[136:151]
    s_waitcnt vmcnt(8)
    s_barrier
    s_add_u32 m0, s31, 0
    s_mov_b32 s35, 0
    buffer_load_dwordx4 v236, s[20:23], s35 offen lds
    s_add_u32 m0, s31, 8192
    s_mov_b32 s35, 0
    buffer_load_dwordx4 v237, s[20:23], s35 offen lds
    s_add_u32 m0, s31, 16384
    s_mov_b32 s35, 0
    buffer_load_dwordx4 v238, s[20:23], s35 offen lds
    s_add_u32 m0, s31, 24576
    s_mov_b32 s35, 0
    buffer_load_dwordx4 v239, s[20:23], s35 offen lds
    s_and_b32 s34, s31, 0xfff
    s_add_u32 m0, s34, 32768
    s_mov_b32 s35, 0
    buffer_load_dwordx4 v240, s[20:23], s35 offen lds
    ds_read_b64_tr_b16 v[200:201], v10 offset:0
    ds_read_b64_tr_b16 v[202:203], v10 offset:2048
    ds_read_b64_tr_b16 v[204:205], v11 offset:0
    ds_read_b64_tr_b16 v[206:207], v11 offset:2048
    ds_read_b64_tr_b16 v[208:209], v12 offset:0
    ds_read_b64_tr_b16 v[210:211], v12 offset:2048
    ds_read_b64_tr_b16 v[212:213], v13 offset:0
    ds_read_b64_tr_b16 v[214:215], v13 offset:2048
    ds_read_b64_tr_b16 v[216:217], v10 offset:4096
    ds_read_b64_tr_b16 v[218:219], v10 offset:6144
    ds_read_b64_tr_b16 v[220:221], v11 offset:4096
    ds_read_b64_tr_b16 v[222:223], v11 offset:6144
    s_nop 7
    v_max3_f32 v18, v120, v121, v122
    v_max3_f32 v18, v18, v123, v124
    v_max3_f32 v18, v18, v125, v126
    v_max3_f32 v18, v18, v127, v128
    v_max3_f32 v18, v18, v129, v130
    v_max3_f32 v18, v18, v131, v132
    v_max3_f32 v18, v18, v133, v134
    v_max3_f32 v18, v18, v135, v136
    v_max3_f32 v18, v18, v137, v138
    v_max3_f32 v18, v18, v139, v140
    v_max3_f32 v18, v18, v141, v142
    v_max3_f32 v18, v18, v143, v144
    v_max3_f32 v18, v18, v145, v146
    v_max3_f32 v18, v18, v147, v148
    v_max3_f32 v18, v18, v149, v150
    v_max_f32 v18, v18, v151
    v_mov_b32 v19, v18
    s_nop 1
    v_permlane32_swap_b32 v18, v19
    v_max_f32 v18, v18, v19
    v_mul_f32 v18, s36, v18
    v_add_f32 v19, 0x41000000, v16
    v_cmp_gt_f32 vcc, v18, v19
    s_nop 4
    s_cbranch_vccz L_skip6
    v_max_f32 v18, v18, v16
    v_sub_f32 v19, v16, v18
    v_exp_f32 v19, v19
    v_mov_b32 v16, v18
    s_nop 0
    v_mul_f32 v17, v17, v19
    v_mul_f32 v56, v56, v19
    v_mul_f32 v57, v57, v19
    v_mul_f32 v58, v58, v19
    v_mul_f32 v59, v59, v19
    v_mul_f32 v60, v60, v19
    v_mul_f32 v61, v61, v19
    v_mul_f32 v62, v62, v19
    v_mul_f32 v63, v63, v19
    v_mul_f32 v64, v64, v19
    v_mul_f32 v65, v65, v19
    v_mul_f32 v66, v66, v19
    v_mul_f32 v67, v67, v19
    v_mul_f32 v68, v68, v19
    v_mul_f32 v69, v69, v19
    v_mul_f32 v70, v70, v19
    v_mul_f32 v71, v71, v19
    v_mul_f32 v72, v72, v19
    v_mul_f32 v73, v73, v19
    v_mul_f32 v74, v74, v19
    v_mul_f32 v75, v75, v19
    v_mul_f32 v76, v76, v19
    v_mul_f32 v77, v77, v19
    v_mul_f32 v78, v78, v19
    v_mul_f32 v79, v79, v19
    v_mul_f32 v80, v80, v19
    v_mul_f32 v81, v81, v19
    v_mul_f32 v82, v82, v19
    v_mul_f32 v83, v83, v19
    v_mul_f32 v84, v84, v19
    v_mul_f32 v85, v85, v19
    v_mul_f32 v86, v86, v19
    v_mul_f32 v87, v87, v19
    v_mul_f32 v88, v88, v19
    v_mul_f32 v89, v89, v19
    v_mul_f32 v90, v90, v19
    v_mul_f32 v91, v91, v19
    v_mul_f32 v92, v92, v19
    v_mul_f32 v93, v93, v19
    v_mul_f32 v94, v94, v19
    v_mul_f32 v95, v95, v19
    v_mul_f32 v96, v96, v19
    v_mul_f32 v97, v97, v19
    v_mul_f32 v98, v98, v19
    v_mul_f32 v99, v99, v19
    v_mul_f32 v100, v100, v19
    v_mul_f32 v101, v101, v19
    v_mul_f32 v102, v102, v19
    v_mul_f32 v103, v103, v19
    v_mul_f32 v104, v104, v19
    v_mul_f32 v105, v105, v19
    v_mul_f32 v106, v106, v19
    v_mul_f32 v107, v107, v19
    v_mul_f32 v108, v108, v19
    v_mul_f32 v109, v109, v19
    v_mul_f32 v110, v110, v19
    v_mul_f32 v111, v111, v19
    v_mul_f32 v112, v112, v19
    v_mul_f32 v113, v113, v19
    v_mul_f32 v114, v114, v19
    v_mul_f32 v115, v115, v19
    v_mul_f32 v116, v116, v19
    v_mul_f32 v117, v117, v19
    v_mul_f32 v118, v118, v19
    v_mul_f32 v119, v119, v19
L_skip6:
    v_fma_f32 v120, v120, s36, -v16
    v_fma_f32 v121, v121, s36, -v16
    v_fma_f32 v122, v122, s36, -v16
    v_fma_f32 v123, v123, s36, -v16
    v_fma_f32 v124, v124, s36, -v16
    v_fma_f32 v125, v125, s36, -v16
    v_fma_f32 v126, v126, s36, -v16
    v_fma_f32 v127, v127, s36, -v16
    v_fma_f32 v128, v128, s36, -v16
    v_fma_f32 v129, v129, s36, -v16
    v_fma_f32 v130, v130, s36, -v16
    v_fma_f32 v131, v131, s36, -v16
    v_fma_f32 v132, v132, s36, -v16
    v_fma_f32 v133, v133, s36, -v16
    v_fma_f32 v134, v134, s36, -v16
    v_fma_f32 v135, v135, s36, -v16
    v_fma_f32 v136, v136, s36, -v16
    v_fma_f32 v137, v137, s36, -v16
    v_fma_f32 v138, v138, s36, -v16
    v_fma_f32 v139, v139, s36, -v16
    v_fma_f32 v140, v140, s36, -v16
    v_fma_f32 v141, v141, s36, -v16
    v_fma_f32 v142, v142, s36, -v16
    v_fma_f32 v143, v143, s36, -v16
    v_fma_f32 v144, v144, s36, -v16
    v_fma_f32 v145, v145, s36, -v16
    v_fma_f32 v146, v146, s36, -v16
    v_fma_f32 v147, v147, s36, -v16
    v_fma_f32 v148, v148, s36, -v16
    v_fma_f32 v149, v149, s36, -v16
    v_fma_f32 v150, v150, s36, -v16
    v_fma_f32 v151, v151, s36, -v16
    v_exp_f32 v120, v120
    v_exp_f32 v121, v121
    v_exp_f32 v122, v122
    v_exp_f32 v123, v123
    v_exp_f32 v124, v124
    v_exp_f32 v125, v125
    v_exp_f32 v126, v126
    v_exp_f32 v127, v127
    v_exp_f32 v128, v128
    v_exp_f32 v129, v129
    v_exp_f32 v130, v130
    v_exp_f32 v131, v131
    v_exp_f32 v132, v132
    v_exp_f32 v133, v133
    v_exp_f32 v134, v134
    v_exp_f32 v135, v135
    v_exp_f32 v136, v136
    v_exp_f32 v137, v137
    v_exp_f32 v138, v138
    v_exp_f32 v139, v139
    v_exp_f32 v140, v140
    v_exp_f32 v141, v141
    v_exp_f32 v142, v142
    v_exp_f32 v143, v143
    v_exp_f32 v144, v144
    v_exp_f32 v145, v145
    v_exp_f32 v146, v146
    v_exp_f32 v147, v147
    v_exp_f32 v148, v148
    v_exp_f32 v149, v149
    v_exp_f32 v150, v150
    v_exp_f32 v151, v151
    s_nop 0
    v_cvt_pk_bf16_f32 v152, v120, v121
    v_cvt_pk_bf16_f32 v153, v122, v123
    v_cvt_pk_bf16_f32 v154, v124, v125
    v_cvt_pk_bf16_f32 v155, v126, v127
    v_cvt_pk_bf16_f32 v156, v128, v129
    v_cvt_pk_bf16_f32 v157, v130, v131
    v_cvt_pk_bf16_f32 v158, v132, v133
    v_cvt_pk_bf16_f32 v159, v134, v135
    v_cvt_pk_bf16_f32 v160, v136, v137
    v_cvt_pk_bf16_f32 v161, v138, v139
    v_cvt_pk_bf16_f32 v162, v140, v141
    v_cvt_pk_bf16_f32 v163, v142, v143
    v_cvt_pk_bf16_f32 v164, v144, v145
    v_cvt_pk_bf16_f32 v165, v146, v147
    v_cvt_pk_bf16_f32 v166, v148, v149
    v_cvt_pk_bf16_f32 v167, v150, v151
    v_add_f32 v20, v120, v121
    v_add_f32 v21, v122, v123
    v_add_f32 v20, v20, v124
    v_add_f32 v21, v21, v125
    v_add_f32 v20, v20, v126
    v_add_f32 v21, v21, v127
    v_add_f32 v20, v20, v128
    v_add_f32 v21, v21, v129
    v_add_f32 v20, v20, v130
    v_add_f32 v21, v21, v131
    v_add_f32 v20, v20, v132
    v_add_f32 v21, v21, v133
    v_add_f32 v20, v20, v134
    v_add_f32 v21, v21, v135
    v_add_f32 v20, v20, v136
    v_add_f32 v21, v21, v137
    v_add_f32 v20, v20, v138
    v_add_f32 v21, v21, v139
    v_add_f32 v20, v20, v140
    v_add_f32 v21, v21, v141
    v_add_f32 v20, v20, v142
    v_add_f32 v21, v21, v143
    v_add_f32 v20, v20, v144
    v_add_f32 v21, v21, v145
    v_add_f32 v20, v20, v146
    v_add_f32 v21, v21, v147
    v_add_f32 v20, v20, v148
    v_add_f32 v21, v21, v149
    v_add_f32 v20, v20, v150
    v_add_f32 v21, v21, v151
    v_add_f32 v17, v17, v20
    v_add_f32 v17, v17, v21
    s_waitcnt lgkmcnt(10)
    v_mfma_f32_32x32x16_bf16 v[56:71], v[200:203], v[152:155], v[56:71]
    ds_read_b64_tr_b16 v[224:225], v12 offset:4096
    ds_read_b64_tr_b16 v[226:227], v12 offset:6144
    s_waitcnt lgkmcnt(10)
    v_mfma_f32_32x32x16_bf16 v[72:87], v[204:207], v[152:155], v[72:87]
    ds_read_b64_tr_b16 v[228:229], v13 offset:4096
    ds_read_b64_tr_b16 v[230:231], v13 offset:6144
    s_waitcnt lgkmcnt(10)
    v_mfma_f32_32x32x16_bf16 v[88:103], v[208:211], v[152:155], v[88:103]
    ds_read_b64_tr_b16 v[200:201], v10 offset:8192
    ds_read_b64_tr_b16 v[202:203], v10 offset:10240
    s_waitcnt lgkmcnt(10)
    v_mfma_f32_32x32x16_bf16 v[104:119], v[212:215], v[152:155], v[104:119]
    ds_read_b64_tr_b16 v[204:205], v11 offset:8192
    ds_read_b64_tr_b16 v[206:207], v11 offset:10240
    s_waitcnt lgkmcnt(10)
    v_mfma_f32_32x32x16_bf16 v[56:71], v[216:219], v[156:159], v[56:71]
    ds_read_b64_tr_b16 v[208:209], v12 offset:8192
    ds_read_b64_tr_b16 v[210:211], v12 offset:10240
    s_waitcnt lgkmcnt(10)
    v_mfma_f32_32x32x16_bf16 v[72:87], v[220:223], v[156:159], v[72:87]
    ds_read_b64_tr_b16 v[212:213], v13 offset:8192
    ds_read_b64_tr_b16 v[214:215], v13 offset:10240
    s_waitcnt lgkmcnt(10)
    v_mfma_f32_32x32x16_bf16 v[88:103], v[224:227], v[156:159], v[88:103]
    ds_read_b64_tr_b16 v[216:217], v10 offset:12288
    ds_read_b64_tr_b16 v[218:219], v10 offset:14336
    s_waitcnt lgkmcnt(10)
    v_mfma_f32_32x32x16_bf16 v[104:119], v[228:231], v[156:159], v[104:119]
    ds_read_b64_tr_b16 v[220:221], v11 offset:12288
    ds_read_b64_tr_b16 v[222:223], v11 offset:14336
    s_waitcnt lgkmcnt(10)
    v_mfma_f32_32x32x16_bf16 v[56:71], v[200:203], v[160:163], v[56:71]
    ds_read_b64_tr_b16 v[224:225], v12 offset:12288
    ds_read_b64_tr_b16 v[226:227], v12 offset:14336
    s_waitcnt lgkmcnt(10)
    v_mfma_f32_32x32x16_bf16 v[72:87], v[204:207], v[160:163], v[72:87]
    ds_read_b64_tr_b16 v[228:229], v13 offset:12288
    ds_read_b64_tr_b16 v[230:231], v13 offset:14336
    s_waitcnt lgkmcnt(10)
    v_mfma_f32_32x32x16_bf16 v[88:103], v[208:211], v[160:163], v[88:103]
    s_waitcnt lgkmcnt(8)
    v_mfma_f32_32x32x16_bf16 v[104:119], v[212:215], v[160:163], v[104:119]
    s_waitcnt lgkmcnt(6)
    v_mfma_f32_32x32x16_bf16 v[56:71], v[216:219], v[164:167], v[56:71]
    s_waitcnt lgkmcnt(4)
    v_mfma_f32_32x32x16_bf16 v[72:87], v[220:223], v[164:167], v[72:87]
    s_waitcnt lgkmcnt(2)
    v_mfma_f32_32x32x16_bf16 v[88:103], v[224:227], v[164:167], v[88:103]
    s_waitcnt lgkmcnt(0)
    v_mfma_f32_32x32x16_bf16 v[104:119], v[228:231], v[164:167], v[104:119]
    s_mov_b32 s42, 65536
    s_cmp_eq_u32 s29, 0
    s_cselect_b32 s42, 65536, s42
    s_mov_b32 s43, 65536
    s_cmp_eq_u32 s29, 0
    s_cselect_b32 s43, 65536, s43
    v_add_u32 v2, s42, v2
    v_add_u32 v3, s42, v3
    v_add_u32 v4, s42, v4
    v_add_u32 v5, s42, v5
    v_add_u32 v6, s42, v6
    v_add_u32 v7, s42, v7
    v_add_u32 v8, s42, v8
    v_add_u32 v9, s42, v9
    v_add_u32 v10, s43, v10
    v_add_u32 v11, s43, v11
    v_add_u32 v12, s43, v12
    v_add_u32 v13, s43, v13
    s_waitcnt vmcnt(9)
    s_barrier
    s_add_u32 m0, s31, 36864
    s_mov_b32 s35, 18432
    buffer_load_dwordx4 v236, s[20:23], s35 offen lds
    s_add_u32 m0, s31, 45056
    s_mov_b32 s35, 18432
    buffer_load_dwordx4 v237, s[20:23], s35 offen lds
    s_add_u32 m0, s31, 53248
    s_mov_b32 s35, 18432
    buffer_load_dwordx4 v238, s[20:23], s35 offen lds
    s_add_u32 m0, s31, 61440
    s_mov_b32 s35, 18432
    buffer_load_dwordx4 v239, s[20:23], s35 offen lds
    s_and_b32 s34, s31, 0xfff
    s_add_u32 m0, s34, 69632
    s_mov_b32 s35, 18432
    buffer_load_dwordx4 v240, s[20:23], s35 offen lds
    ds_read_b128 v[168:171], v2 offset:0
    ds_read_b128 v[172:175], v3 offset:0
    ds_read_b128 v[176:179], v4 offset:0
    ds_read_b128 v[180:183], v5 offset:0
    ds_read_b128 v[184:187], v6 offset:0
    ds_read_b128 v[188:191], v7 offset:0
    ds_read_b128 v[192:195], v8 offset:0
    ds_read_b128 v[196:199], v9 offset:0
    s_waitcnt lgkmcnt(7)
    v_mfma_f32_32x32x16_bf16 v[120:135], v[168:171], v[24:27], 0
    ds_read_b128 v[168:171], v2 offset:8192
    s_waitcnt lgkmcnt(7)
    v_mfma_f32_32x32x16_bf16 v[120:135], v[172:175], v[28:31], v[120:135]
    ds_read_b128 v[172:175], v3 offset:8192
    s_waitcnt lgkmcnt(7)
    v_mfma_f32_32x32x16_bf16 v[120:135], v[176:179], v[32:35], v[120:135]
    ds_read_b128 v[176:179], v4 offset:8192
    s_waitcnt lgkmcnt(7)
    v_mfma_f32_32x32x16_bf16 v[120:135], v[180:183], v[36:39], v[120:135]
    ds_read_b128 v[180:183], v5 offset:8192
    s_waitcnt lgkmcnt(7)
    v_mfma_f32_32x32x16_bf16 v[120:135], v[184:187], v[40:43], v[120:135]
    ds_read_b128 v[184:187], v6 offset:8192
    s_waitcnt lgkmcnt(7)
    v_mfma_f32_32x32x16_bf16 v[120:135], v[188:191], v[44:47], v[120:135]
    ds_read_b128 v[188:191], v7 offset:8192
    s_waitcnt lgkmcnt(7)
    v_mfma_f32_32x32x16_bf16 v[120:135], v[192:195], v[48:51], v[120:135]
    ds_read_b128 v[192:195], v8 offset:8192
    s_waitcnt lgkmcnt(7)
    v_mfma_f32_32x32x16_bf16 v[120:135], v[196:199], v[52:55], v[120:135]
    ds_read_b128 v[196:199], v9 offset:8192
    s_waitcnt lgkmcnt(7)
    v_mfma_f32_32x32x16_bf16 v[136:151], v[168:171], v[24:27], 0
    s_waitcnt lgkmcnt(6)
    v_mfma_f32_32x32x16_bf16 v[136:151], v[172:175], v[28:31], v[136:151]
    s_waitcnt lgkmcnt(5)
    v_mfma_f32_32x32x16_bf16 v[136:151], v[176:179], v[32:35], v[136:151]
    s_waitcnt lgkmcnt(4)
    v_mfma_f32_32x32x16_bf16 v[136:151], v[180:183], v[36:39], v[136:151]
    s_waitcnt lgkmcnt(3)
    v_mfma_f32_32x32x16_bf16 v[136:151], v[184:187], v[40:43], v[136:151]
    s_waitcnt lgkmcnt(2)
    v_mfma_f32_32x32x16_bf16 v[136:151], v[188:191], v[44:47], v[136:151]
    s_waitcnt lgkmcnt(1)
    v_mfma_f32_32x32x16_bf16 v[136:151], v[192:195], v[48:51], v[136:151]
    s_waitcnt lgkmcnt(0)
    v_mfma_f32_32x32x16_bf16 v[136:151], v[196:199], v[52:55], v[136:151]
    s_waitcnt vmcnt(10)
    s_barrier
    ds_read_b64_tr_b16 v[200:201], v10 offset:0
    ds_read_b64_tr_b16 v[202:203], v10 offset:2048
    ds_read_b64_tr_b16 v[204:205], v11 offset:0
    ds_read_b64_tr_b16 v[206:207], v11 offset:2048
    ds_read_b64_tr_b16 v[208:209], v12 offset:0
    ds_read_b64_tr_b16 v[210:211], v12 offset:2048
    ds_read_b64_tr_b16 v[212:213], v13 offset:0
    ds_read_b64_tr_b16 v[214:215], v13 offset:2048
    ds_read_b64_tr_b16 v[216:217], v10 offset:4096
    ds_read_b64_tr_b16 v[218:219], v10 offset:6144
    ds_read_b64_tr_b16 v[220:221], v11 offset:4096
    ds_read_b64_tr_b16 v[222:223], v11 offset:6144
    s_nop 7
    v_max3_f32 v18, v120, v121, v122
    v_max3_f32 v18, v18, v123, v124
    v_max3_f32 v18, v18, v125, v126
    v_max3_f32 v18, v18, v127, v128
    v_max3_f32 v18, v18, v129, v130
    v_max3_f32 v18, v18, v131, v132
    v_max3_f32 v18, v18, v133, v134
    v_max3_f32 v18, v18, v135, v136
    v_max3_f32 v18, v18, v137, v138
    v_max3_f32 v18, v18, v139, v140
    v_max3_f32 v18, v18, v141, v142
    v_max3_f32 v18, v18, v143, v144
    v_max3_f32 v18, v18, v145, v146
    v_max3_f32 v18, v18, v147, v148
    v_max3_f32 v18, v18, v149, v150
    v_max_f32 v18, v18, v151
    v_mov_b32 v19, v18
    s_nop 1
    v_permlane32_swap_b32 v18, v19
    v_max_f32 v18, v18, v19
    v_mul_f32 v18, s36, v18
    v_add_f32 v19, 0x41000000, v16
    v_cmp_gt_f32 vcc, v18, v19
    s_nop 4
    s_cbranch_vccz L_skip7
    v_max_f32 v18, v18, v16
    v_sub_f32 v19, v16, v18
    v_exp_f32 v19, v19
    v_mov_b32 v16, v18
    s_nop 0
    v_mul_f32 v17, v17, v19
    v_mul_f32 v56, v56, v19
    v_mul_f32 v57, v57, v19
    v_mul_f32 v58, v58, v19
    v_mul_f32 v59, v59, v19
    v_mul_f32 v60, v60, v19
    v_mul_f32 v61, v61, v19
    v_mul_f32 v62, v62, v19
    v_mul_f32 v63, v63, v19
    v_mul_f32 v64, v64, v19
    v_mul_f32 v65, v65, v19
    v_mul_f32 v66, v66, v19
    v_mul_f32 v67, v67, v19
    v_mul_f32 v68, v68, v19
    v_mul_f32 v69, v69, v19
    v_mul_f32 v70, v70, v19
    v_mul_f32 v71, v71, v19
    v_mul_f32 v72, v72, v19
    v_mul_f32 v73, v73, v19
    v_mul_f32 v74, v74, v19
    v_mul_f32 v75, v75, v19
    v_mul_f32 v76, v76, v19
    v_mul_f32 v77, v77, v19
    v_mul_f32 v78, v78, v19
    v_mul_f32 v79, v79, v19
    v_mul_f32 v80, v80, v19
    v_mul_f32 v81, v81, v19
    v_mul_f32 v82, v82, v19
    v_mul_f32 v83, v83, v19
    v_mul_f32 v84, v84, v19
    v_mul_f32 v85, v85, v19
    v_mul_f32 v86, v86, v19
    v_mul_f32 v87, v87, v19
    v_mul_f32 v88, v88, v19
    v_mul_f32 v89, v89, v19
    v_mul_f32 v90, v90, v19
    v_mul_f32 v91, v91, v19
    v_mul_f32 v92, v92, v19
    v_mul_f32 v93, v93, v19
    v_mul_f32 v94, v94, v19
    v_mul_f32 v95, v95, v19
    v_mul_f32 v96, v96, v19
    v_mul_f32 v97, v97, v19
    v_mul_f32 v98, v98, v19
    v_mul_f32 v99, v99, v19
    v_mul_f32 v100, v100, v19
    v_mul_f32 v101, v101, v19
    v_mul_f32 v102, v102, v19
    v_mul_f32 v103, v103, v19
    v_mul_f32 v104, v104, v19
    v_mul_f32 v105, v105, v19
    v_mul_f32 v106, v106, v19
    v_mul_f32 v107, v107, v19
    v_mul_f32 v108, v108, v19
    v_mul_f32 v109, v109, v19
    v_mul_f32 v110, v110, v19
    v_mul_f32 v111, v111, v19
    v_mul_f32 v112, v112, v19
    v_mul_f32 v113, v113, v19
    v_mul_f32 v114, v114, v19
    v_mul_f32 v115, v115, v19
    v_mul_f32 v116, v116, v19
    v_mul_f32 v117, v117, v19
    v_mul_f32 v118, v118, v19
    v_mul_f32 v119, v119, v19
L_skip7:
    v_fma_f32 v120, v120, s36, -v16
    v_fma_f32 v121, v121, s36, -v16
    v_fma_f32 v122, v122, s36, -v16
    v_fma_f32 v123, v123, s36, -v16
    v_fma_f32 v124, v124, s36, -v16
    v_fma_f32 v125, v125, s36, -v16
    v_fma_f32 v126, v126, s36, -v16
    v_fma_f32 v127, v127, s36, -v16
    v_fma_f32 v128, v128, s36, -v16
    v_fma_f32 v129, v129, s36, -v16
    v_fma_f32 v130, v130, s36, -v16
    v_fma_f32 v131, v131, s36, -v16
    v_fma_f32 v132, v132, s36, -v16
    v_fma_f32 v133, v133, s36, -v16
    v_fma_f32 v134, v134, s36, -v16
    v_fma_f32 v135, v135, s36, -v16
    v_fma_f32 v136, v136, s36, -v16
    v_fma_f32 v137, v137, s36, -v16
    v_fma_f32 v138, v138, s36, -v16
    v_fma_f32 v139, v139, s36, -v16
    v_fma_f32 v140, v140, s36, -v16
    v_fma_f32 v141, v141, s36, -v16
    v_fma_f32 v142, v142, s36, -v16
    v_fma_f32 v143, v143, s36, -v16
    v_fma_f32 v144, v144, s36, -v16
    v_fma_f32 v145, v145, s36, -v16
    v_fma_f32 v146, v146, s36, -v16
    v_fma_f32 v147, v147, s36, -v16
    v_fma_f32 v148, v148, s36, -v16
    v_fma_f32 v149, v149, s36, -v16
    v_fma_f32 v150, v150, s36, -v16
    v_fma_f32 v151, v151, s36, -v16
    v_exp_f32 v120, v120
    v_exp_f32 v121, v121
    v_exp_f32 v122, v122
    v_exp_f32 v123, v123
    v_exp_f32 v124, v124
    v_exp_f32 v125, v125
    v_exp_f32 v126, v126
    v_exp_f32 v127, v127
    v_exp_f32 v128, v128
    v_exp_f32 v129, v129
    v_exp_f32 v130, v130
    v_exp_f32 v131, v131
    v_exp_f32 v132, v132
    v_exp_f32 v133, v133
    v_exp_f32 v134, v134
    v_exp_f32 v135, v135
    v_exp_f32 v136, v136
    v_exp_f32 v137, v137
    v_exp_f32 v138, v138
    v_exp_f32 v139, v139
    v_exp_f32 v140, v140
    v_exp_f32 v141, v141
    v_exp_f32 v142, v142
    v_exp_f32 v143, v143
    v_exp_f32 v144, v144
    v_exp_f32 v145, v145
    v_exp_f32 v146, v146
    v_exp_f32 v147, v147
    v_exp_f32 v148, v148
    v_exp_f32 v149, v149
    v_exp_f32 v150, v150
    v_exp_f32 v151, v151
    s_nop 0
    v_cvt_pk_bf16_f32 v152, v120, v121
    v_cvt_pk_bf16_f32 v153, v122, v123
    v_cvt_pk_bf16_f32 v154, v124, v125
    v_cvt_pk_bf16_f32 v155, v126, v127
    v_cvt_pk_bf16_f32 v156, v128, v129
    v_cvt_pk_bf16_f32 v157, v130, v131
    v_cvt_pk_bf16_f32 v158, v132, v133
    v_cvt_pk_bf16_f32 v159, v134, v135
    v_cvt_pk_bf16_f32 v160, v136, v137
    v_cvt_pk_bf16_f32 v161, v138, v139
    v_cvt_pk_bf16_f32 v162, v140, v141
    v_cvt_pk_bf16_f32 v163, v142, v143
    v_cvt_pk_bf16_f32 v164, v144, v145
    v_cvt_pk_bf16_f32 v165, v146, v147
    v_cvt_pk_bf16_f32 v166, v148, v149
    v_cvt_pk_bf16_f32 v167, v150, v151
    v_add_f32 v20, v120, v121
    v_add_f32 v21, v122, v123
    v_add_f32 v20, v20, v124
    v_add_f32 v21, v21, v125
    v_add_f32 v20, v20, v126
    v_add_f32 v21, v21, v127
    v_add_f32 v20, v20, v128
    v_add_f32 v21, v21, v129
    v_add_f32 v20, v20, v130
    v_add_f32 v21, v21, v131
    v_add_f32 v20, v20, v132
    v_add_f32 v21, v21, v133
    v_add_f32 v20, v20, v134
    v_add_f32 v21, v21, v135
    v_add_f32 v20, v20, v136
    v_add_f32 v21, v21, v137
    v_add_f32 v20, v20, v138
    v_add_f32 v21, v21, v139
    v_add_f32 v20, v20, v140
    v_add_f32 v21, v21, v141
    v_add_f32 v20, v20, v142
    v_add_f32 v21, v21, v143
    v_add_f32 v20, v20, v144
    v_add_f32 v21, v21, v145
    v_add_f32 v20, v20, v146
    v_add_f32 v21, v21, v147
    v_add_f32 v20, v20, v148
    v_add_f32 v21, v21, v149
    v_add_f32 v20, v20, v150
    v_add_f32 v21, v21, v151
    v_add_f32 v17, v17, v20
    v_add_f32 v17, v17, v21
    s_waitcnt lgkmcnt(10)
    v_mfma_f32_32x32x16_bf16 v[56:71], v[200:203], v[152:155], v[56:71]
    ds_read_b64_tr_b16 v[224:225], v12 offset:4096
    ds_read_b64_tr_b16 v[226:227], v12 offset:6144
    s_waitcnt lgkmcnt(10)
    v_mfma_f32_32x32x16_bf16 v[72:87], v[204:207], v[152:155], v[72:87]
    ds_read_b64_tr_b16 v[228:229], v13 offset:4096
    ds_read_b64_tr_b16 v[230:231], v13 offset:6144
    s_waitcnt lgkmcnt(10)
    v_mfma_f32_32x32x16_bf16 v[88:103], v[208:211], v[152:155], v[88:103]
    ds_read_b64_tr_b16 v[200:201], v10 offset:8192
    ds_read_b64_tr_b16 v[202:203], v10 offset:10240
    s_waitcnt lgkmcnt(10)
    v_mfma_f32_32x32x16_bf16 v[104:119], v[212:215], v[152:155], v[104:119]
    ds_read_b64_tr_b16 v[204:205], v11 offset:8192
    ds_read_b64_tr_b16 v[206:207], v11 offset:10240
    s_waitcnt lgkmcnt(10)
    v_mfma_f32_32x32x16_bf16 v[56:71], v[216:219], v[156:159], v[56:71]
    ds_read_b64_tr_b16 v[208:209], v12 offset:8192
    ds_read_b64_tr_b16 v[210:211], v12 offset:10240
    s_waitcnt lgkmcnt(10)
    v_mfma_f32_32x32x16_bf16 v[72:87], v[220:223], v[156:159], v[72:87]
    ds_read_b64_tr_b16 v[212:213], v13 offset:8192
    ds_read_b64_tr_b16 v[214:215], v13 offset:10240
    s_waitcnt lgkmcnt(10)
    v_mfma_f32_32x32x16_bf16 v[88:103], v[224:227], v[156:159], v[88:103]
    ds_read_b64_tr_b16 v[216:217], v10 offset:12288
    ds_read_b64_tr_b16 v[218:219], v10 offset:14336
    s_waitcnt lgkmcnt(10)
    v_mfma_f32_32x32x16_bf16 v[104:119], v[228:231], v[156:159], v[104:119]
    ds_read_b64_tr_b16 v[220:221], v11 offset:12288
    ds_read_b64_tr_b16 v[222:223], v11 offset:14336
    s_waitcnt lgkmcnt(10)
    v_mfma_f32_32x32x16_bf16 v[56:71], v[200:203], v[160:163], v[56:71]
    ds_read_b64_tr_b16 v[224:225], v12 offset:12288
    ds_read_b64_tr_b16 v[226:227], v12 offset:14336
    s_waitcnt lgkmcnt(10)
    v_mfma_f32_32x32x16_bf16 v[72:87], v[204:207], v[160:163], v[72:87]
    ds_read_b64_tr_b16 v[228:229], v13 offset:12288
    ds_read_b64_tr_b16 v[230:231], v13 offset:14336
    s_waitcnt lgkmcnt(10)
    v_mfma_f32_32x32x16_bf16 v[88:103], v[208:211], v[160:163], v[88:103]
    s_waitcnt lgkmcnt(8)
    v_mfma_f32_32x32x16_bf16 v[104:119], v[212:215], v[160:163], v[104:119]
    s_waitcnt lgkmcnt(6)
    v_mfma_f32_32x32x16_bf16 v[56:71], v[216:219], v[164:167], v[56:71]
    s_waitcnt lgkmcnt(4)
    v_mfma_f32_32x32x16_bf16 v[72:87], v[220:223], v[164:167], v[72:87]
    s_waitcnt lgkmcnt(2)
    v_mfma_f32_32x32x16_bf16 v[88:103], v[224:227], v[164:167], v[88:103]
    s_waitcnt lgkmcnt(0)
    v_mfma_f32_32x32x16_bf16 v[104:119], v[228:231], v[164:167], v[104:119]
    s_nop 7
    s_nop 7
    v_mov_b32 v19, v17
    s_nop 1
    v_permlane32_swap_b32 v17, v19
    v_add_f32 v17, v17, v19
    s_barrier
    s_lshl_b32 s32, s28, 13
    s_add_u32 s32, s32, 73728
    v_add_u32 v22, s32, v243
    s_xor_b32 s32, s32, 0
    s_xor_b32 s33, s28, 4
    s_lshl_b32 s32, s33, 13
    s_add_u32 s32, s32, 73728
    v_add_u32 v23, s32, v243
    s_lshl_b32 s32, s28, 9
    s_add_u32 s32, s32, 139264
    v_lshl_add_u32 v20, v1, 2, s32
    s_lshl_b32 s32, s33, 9
    s_add_u32 s32, s32, 139264
    v_lshl_add_u32 v21, v1, 2, s32
    ds_write_b32 v20, v16
    ds_write_b32 v20, v17 offset:256
    s_cmp_eq_u32 s29, 0
    s_cbranch_scc1 L_mergeA
    ds_write_b128 v22, v[56:59] offset:0
    ds_write_b128 v22, v[60:63] offset:1024
    ds_write_b128 v22, v[64:67] offset:2048
    ds_write_b128 v22, v[68:71] offset:3072
    ds_write_b128 v22, v[72:75] offset:4096
    ds_write_b128 v22, v[76:79] offset:5120
    ds_write_b128 v22, v[80:83] offset:6144
    ds_write_b128 v22, v[84:87] offset:7168
    s_waitcnt lgkmcnt(0)
    s_barrier
    ds_read_b32 v18, v21
    ds_read_b32 v19, v21 offset:256
    ds_read_b128 v[120:123], v23 offset:0
    ds_read_b128 v[124:127], v23 offset:1024
    ds_read_b128 v[128:131], v23 offset:2048
    ds_read_b128 v[132:135], v23 offset:3072
    ds_read_b128 v[136:139], v23 offset:4096
    ds_read_b128 v[140:143], v23 offset:5120
    ds_read_b128 v[144:147], v23 offset:6144
    ds_read_b128 v[148:151], v23 offset:7168
    s_waitcnt lgkmcnt(8)
    v_max_f32 v20, v16, v18
    v_sub_f32 v16, v16, v20
    v_sub_f32 v18, v18, v20
    v_exp_f32 v16, v16
    v_exp_f32 v18, v18
    s_nop 0
    v_mul_f32 v17, v17, v16
    v_fma_f32 v17, v19, v18, v17
    v_rcp_f32 v17, v17
    s_nop 0
    v_mul_f32 v16, v16, v17
    v_mul_f32 v18, v18, v17
    s_waitcnt lgkmcnt(0)
    v_mul_f32 v88, v88, v16
    v_fma_f32 v88, v120, v18, v88
    v_mul_f32 v89, v89, v16
    v_fma_f32 v89, v121, v18, v89
    v_mul_f32 v90, v90, v16
    v_fma_f32 v90, v122, v18, v90
    v_mul_f32 v91, v91, v16
    v_fma_f32 v91, v123, v18, v91
    v_mul_f32 v92, v92, v16
    v_fma_f32 v92, v124, v18, v92
    v_mul_f32 v93, v93, v16
    v_fma_f32 v93, v125, v18, v93
    v_mul_f32 v94, v94, v16
    v_fma_f32 v94, v126, v18, v94
    v_mul_f32 v95, v95, v16
    v_fma_f32 v95, v127, v18, v95
    v_mul_f32 v96, v96, v16
    v_fma_f32 v96, v128, v18, v96
    v_mul_f32 v97, v97, v16
    v_fma_f32 v97, v129, v18, v97
    v_mul_f32 v98, v98, v16
    v_fma_f32 v98, v130, v18, v98
    v_mul_f32 v99, v99, v16
    v_fma_f32 v99, v131, v18, v99
    v_mul_f32 v100, v100, v16
    v_fma_f32 v100, v132, v18, v100
    v_mul_f32 v101, v101, v16
    v_fma_f32 v101, v133, v18, v101
    v_mul_f32 v102, v102, v16
    v_fma_f32 v102, v134, v18, v102
    v_mul_f32 v103, v103, v16
    v_fma_f32 v103, v135, v18, v103
    v_mul_f32 v104, v104, v16
    v_fma_f32 v104, v136, v18, v104
    v_mul_f32 v105, v105, v16
    v_fma_f32 v105, v137, v18, v105
    v_mul_f32 v106, v106, v16
    v_fma_f32 v106, v138, v18, v106
    v_mul_f32 v107, v107, v16
    v_fma_f32 v107, v139, v18, v107
    v_mul_f32 v108, v108, v16
    v_fma_f32 v108, v140, v18, v108
    v_mul_f32 v109, v109, v16
    v_fma_f32 v109, v141, v18, v109
    v_mul_f32 v110, v110, v16
    v_fma_f32 v110, v142, v18, v110
    v_mul_f32 v111, v111, v16
    v_fma_f32 v111, v143, v18, v111
    v_mul_f32 v112, v112, v16
    v_fma_f32 v112, v144, v18, v112
    v_mul_f32 v113, v113, v16
    v_fma_f32 v113, v145, v18, v113
    v_mul_f32 v114, v114, v16
    v_fma_f32 v114, v146, v18, v114
    v_mul_f32 v115, v115, v16
    v_fma_f32 v115, v147, v18, v115
    v_mul_f32 v116, v116, v16
    v_fma_f32 v116, v148, v18, v116
    v_mul_f32 v117, v117, v16
    v_fma_f32 v117, v149, v18, v117
    v_mul_f32 v118, v118, v16
    v_fma_f32 v118, v150, v18, v118
    v_mul_f32 v119, v119, v16
    v_fma_f32 v119, v151, v18, v119
    v_cvt_pk_bf16_f32 v40, v88, v89
    v_cvt_pk_bf16_f32 v41, v90, v91
    v_cvt_pk_bf16_f32 v42, v92, v93
    v_cvt_pk_bf16_f32 v43, v94, v95
    v_cvt_pk_bf16_f32 v44, v96, v97
    v_cvt_pk_bf16_f32 v45, v98, v99
    v_cvt_pk_bf16_f32 v46, v100, v101
    v_cvt_pk_bf16_f32 v47, v102, v103
    v_cvt_pk_bf16_f32 v48, v104, v105
    v_cvt_pk_bf16_f32 v49, v106, v107
    v_cvt_pk_bf16_f32 v50, v108, v109
    v_cvt_pk_bf16_f32 v51, v110, v111
    v_cvt_pk_bf16_f32 v52, v112, v113
    v_cvt_pk_bf16_f32 v53, v114, v115
    v_cvt_pk_bf16_f32 v54, v116, v117
    v_cvt_pk_bf16_f32 v55, v118, v119
    ds_write_b128 v23, v[40:43] offset:0
    ds_write_b128 v23, v[44:47] offset:1024
    ds_write_b128 v23, v[48:51] offset:2048
    ds_write_b128 v23, v[52:55] offset:3072
    s_waitcnt lgkmcnt(0)
    s_barrier
    ds_read_b128 v[24:27], v22 offset:0
    ds_read_b128 v[28:31], v22 offset:1024
    ds_read_b128 v[32:35], v22 offset:2048
    ds_read_b128 v[36:39], v22 offset:3072
    s_waitcnt lgkmcnt(0)
    s_branch L_mergeDone
L_mergeA:
    ds_write_b128 v22, v[88:91] offset:0
    ds_write_b128 v22, v[92:95] offset:1024
    ds_write_b128 v22, v[96:99] offset:2048
    ds_write_b128 v22, v[100:103] offset:3072
    ds_write_b128 v22, v[104:107] offset:4096
    ds_write_b128 v22, v[108:111] offset:5120
    ds_write_b128 v22, v[112:115] offset:6144
    ds_write_b128 v22, v[116:119] offset:7168
    s_waitcnt lgkmcnt(0)
    s_barrier
    ds_read_b32 v18, v21
    ds_read_b32 v19, v21 offset:256
    ds_read_b128 v[120:123], v23 offset:0
    ds_read_b128 v[124:127], v23 offset:1024
    ds_read_b128 v[128:131], v23 offset:2048
    ds_read_b128 v[132:135], v23 offset:3072
    ds_read_b128 v[136:139], v23 offset:4096
    ds_read_b128 v[140:143], v23 offset:5120
    ds_read_b128 v[144:147], v23 offset:6144
    ds_read_b128 v[148:151], v23 offset:7168
    s_waitcnt lgkmcnt(8)
    v_max_f32 v20, v16, v18
    v_sub_f32 v16, v16, v20
    v_sub_f32 v18, v18, v20
    v_exp_f32 v16, v16
    v_exp_f32 v18, v18
    s_nop 0
    v_mul_f32 v17, v17, v16
    v_fma_f32 v17, v19, v18, v17
    v_rcp_f32 v17, v17
    s_nop 0
    v_mul_f32 v16, v16, v17
    v_mul_f32 v18, v18, v17
    s_waitcnt lgkmcnt(0)
    v_mul_f32 v56, v56, v16
    v_fma_f32 v56, v120, v18, v56
    v_mul_f32 v57, v57, v16
    v_fma_f32 v57, v121, v18, v57
    v_mul_f32 v58, v58, v16
    v_fma_f32 v58, v122, v18, v58
    v_mul_f32 v59, v59, v16
    v_fma_f32 v59, v123, v18, v59
    v_mul_f32 v60, v60, v16
    v_fma_f32 v60, v124, v18, v60
    v_mul_f32 v61, v61, v16
    v_fma_f32 v61, v125, v18, v61
    v_mul_f32 v62, v62, v16
    v_fma_f32 v62, v126, v18, v62
    v_mul_f32 v63, v63, v16
    v_fma_f32 v63, v127, v18, v63
    v_mul_f32 v64, v64, v16
    v_fma_f32 v64, v128, v18, v64
    v_mul_f32 v65, v65, v16
    v_fma_f32 v65, v129, v18, v65
    v_mul_f32 v66, v66, v16
    v_fma_f32 v66, v130, v18, v66
    v_mul_f32 v67, v67, v16
    v_fma_f32 v67, v131, v18, v67
    v_mul_f32 v68, v68, v16
    v_fma_f32 v68, v132, v18, v68
    v_mul_f32 v69, v69, v16
    v_fma_f32 v69, v133, v18, v69
    v_mul_f32 v70, v70, v16
    v_fma_f32 v70, v134, v18, v70
    v_mul_f32 v71, v71, v16
    v_fma_f32 v71, v135, v18, v71
    v_mul_f32 v72, v72, v16
    v_fma_f32 v72, v136, v18, v72
    v_mul_f32 v73, v73, v16
    v_fma_f32 v73, v137, v18, v73
    v_mul_f32 v74, v74, v16
    v_fma_f32 v74, v138, v18, v74
    v_mul_f32 v75, v75, v16
    v_fma_f32 v75, v139, v18, v75
    v_mul_f32 v76, v76, v16
    v_fma_f32 v76, v140, v18, v76
    v_mul_f32 v77, v77, v16
    v_fma_f32 v77, v141, v18, v77
    v_mul_f32 v78, v78, v16
    v_fma_f32 v78, v142, v18, v78
    v_mul_f32 v79, v79, v16
    v_fma_f32 v79, v143, v18, v79
    v_mul_f32 v80, v80, v16
    v_fma_f32 v80, v144, v18, v80
    v_mul_f32 v81, v81, v16
    v_fma_f32 v81, v145, v18, v81
    v_mul_f32 v82, v82, v16
    v_fma_f32 v82, v146, v18, v82
    v_mul_f32 v83, v83, v16
    v_fma_f32 v83, v147, v18, v83
    v_mul_f32 v84, v84, v16
    v_fma_f32 v84, v148, v18, v84
    v_mul_f32 v85, v85, v16
    v_fma_f32 v85, v149, v18, v85
    v_mul_f32 v86, v86, v16
    v_fma_f32 v86, v150, v18, v86
    v_mul_f32 v87, v87, v16
    v_fma_f32 v87, v151, v18, v87
    v_cvt_pk_bf16_f32 v24, v56, v57
    v_cvt_pk_bf16_f32 v25, v58, v59
    v_cvt_pk_bf16_f32 v26, v60, v61
    v_cvt_pk_bf16_f32 v27, v62, v63
    v_cvt_pk_bf16_f32 v28, v64, v65
    v_cvt_pk_bf16_f32 v29, v66, v67
    v_cvt_pk_bf16_f32 v30, v68, v69
    v_cvt_pk_bf16_f32 v31, v70, v71
    v_cvt_pk_bf16_f32 v32, v72, v73
    v_cvt_pk_bf16_f32 v33, v74, v75
    v_cvt_pk_bf16_f32 v34, v76, v77
    v_cvt_pk_bf16_f32 v35, v78, v79
    v_cvt_pk_bf16_f32 v36, v80, v81
    v_cvt_pk_bf16_f32 v37, v82, v83
    v_cvt_pk_bf16_f32 v38, v84, v85
    v_cvt_pk_bf16_f32 v39, v86, v87
    ds_write_b128 v23, v[24:27] offset:0
    ds_write_b128 v23, v[28:31] offset:1024
    ds_write_b128 v23, v[32:35] offset:2048
    ds_write_b128 v23, v[36:39] offset:3072
    s_waitcnt lgkmcnt(0)
    s_barrier
    ds_read_b128 v[40:43], v22 offset:0
    ds_read_b128 v[44:47], v22 offset:1024
    ds_read_b128 v[48:51], v22 offset:2048
    ds_read_b128 v[52:55], v22 offset:3072
    s_waitcnt lgkmcnt(0)
L_mergeDone:
    s_barrier
    s_add_u32 m0, s31, 73728
    s_mov_b32 s35, 36864
    buffer_load_dwordx4 v236, s[20:23], s35 offen lds
    s_add_u32 m0, s31, 81920
    s_mov_b32 s35, 36864
    buffer_load_dwordx4 v237, s[20:23], s35 offen lds
    s_add_u32 m0, s31, 90112
    s_mov_b32 s35, 36864
    buffer_load_dwordx4 v238, s[20:23], s35 offen lds
    s_add_u32 m0, s31, 98304
    s_mov_b32 s35, 36864
    buffer_load_dwordx4 v239, s[20:23], s35 offen lds
    s_and_b32 s34, s31, 0xfff
    s_add_u32 m0, s34, 106496
    s_mov_b32 s35, 36864
    buffer_load_dwordx4 v240, s[20:23], s35 offen lds
    s_add_u32 m0, s31, 110592
    s_mov_b32 s35, 55296
    buffer_load_dwordx4 v236, s[20:23], s35 offen lds
    s_add_u32 m0, s31, 118784
    s_mov_b32 s35, 55296
    buffer_load_dwordx4 v237, s[20:23], s35 offen lds
    s_add_u32 m0, s31, 126976
    s_mov_b32 s35, 55296
    buffer_load_dwordx4 v238, s[20:23], s35 offen lds
    s_add_u32 m0, s31, 135168
    s_mov_b32 s35, 55296
    buffer_load_dwordx4 v239, s[20:23], s35 offen lds
    s_and_b32 s34, s31, 0xfff
    s_add_u32 m0, s34, 143360
    s_mov_b32 s35, 55296
    buffer_load_dwordx4 v240, s[20:23], s35 offen lds
    s_waitcnt vmcnt(15)
    s_barrier
    v_add_u32 v18, 0, v241
    ds_read_b64_tr_b16 v[200:201], v18 offset:0
    ds_read_b64_tr_b16 v[202:203], v18 offset:9216
    ds_read_b64_tr_b16 v[204:205], v18 offset:64
    ds_read_b64_tr_b16 v[206:207], v18 offset:9280
    ds_read_b64_tr_b16 v[208:209], v18 offset:128
    ds_read_b64_tr_b16 v[210:211], v18 offset:9344
    ds_read_b64_tr_b16 v[212:213], v18 offset:192
    ds_read_b64_tr_b16 v[214:215], v18 offset:9408
    ds_read_b64_tr_b16 v[216:217], v18 offset:256
    ds_read_b64_tr_b16 v[218:219], v18 offset:9472
    ds_read_b64_tr_b16 v[220:221], v18 offset:320
    ds_read_b64_tr_b16 v[222:223], v18 offset:9536
    ds_read_b64_tr_b16 v[224:225], v18 offset:384
    ds_read_b64_tr_b16 v[226:227], v18 offset:9600
    s_waitcnt lgkmcnt(12)
    v_mfma_f32_32x32x16_bf16 v[56:71], v[200:203], v[24:27], 0
    ds_read_b64_tr_b16 v[228:229], v18 offset:448
    ds_read_b64_tr_b16 v[230:231], v18 offset:9664
    s_waitcnt lgkmcnt(12)
    v_mfma_f32_32x32x16_bf16 v[72:87], v[204:207], v[24:27], 0
    ds_read_b64_tr_b16 v[200:201], v18 offset:512
    ds_read_b64_tr_b16 v[202:203], v18 offset:9728
    s_waitcnt lgkmcnt(12)
    v_mfma_f32_32x32x16_bf16 v[88:103], v[208:211], v[24:27], 0
    s_waitcnt lgkmcnt(10)
    v_mfma_f32_32x32x16_bf16 v[104:119], v[212:215], v[24:27], 0
    s_waitcnt lgkmcnt(8)
    v_mfma_f32_32x32x16_bf16 v[120:135], v[216:219], v[24:27], 0
    s_waitcnt lgkmcnt(6)
    v_mfma_f32_32x32x16_bf16 v[136:151], v[220:223], v[24:27], 0
    s_waitcnt lgkmcnt(4)
    v_mfma_f32_32x32x16_bf16 v[152:167], v[224:227], v[24:27], 0
    s_waitcnt lgkmcnt(2)
    v_mfma_f32_32x32x16_bf16 v[168:183], v[228:231], v[24:27], 0
    s_waitcnt lgkmcnt(0)
    v_mfma_f32_32x32x16_bf16 v[184:199], v[200:203], v[24:27], 0
    s_waitcnt vmcnt(10)
    s_barrier
    s_add_u32 m0, s31, 0
    s_mov_b32 s35, 73728
    buffer_load_dwordx4 v236, s[20:23], s35 offen lds
    s_add_u32 m0, s31, 8192
    s_mov_b32 s35, 73728
    buffer_load_dwordx4 v237, s[20:23], s35 offen lds
    s_add_u32 m0, s31, 16384
    s_mov_b32 s35, 73728
    buffer_load_dwordx4 v238, s[20:23], s35 offen lds
    s_add_u32 m0, s31, 24576
    s_mov_b32 s35, 73728
    buffer_load_dwordx4 v239, s[20:23], s35 offen lds
    s_and_b32 s34, s31, 0xfff
    s_add_u32 m0, s34, 32768
    s_mov_b32 s35, 73728
    buffer_load_dwordx4 v240, s[20:23], s35 offen lds
    v_add_u32 v18, 36864, v241
    ds_read_b64_tr_b16 v[200:201], v18 offset:0
    ds_read_b64_tr_b16 v[202:203], v18 offset:9216
    ds_read_b64_tr_b16 v[204:205], v18 offset:64
    ds_read_b64_tr_b16 v[206:207], v18 offset:9280
    ds_read_b64_tr_b16 v[208:209], v18 offset:128
    ds_read_b64_tr_b16 v[210:211], v18 offset:9344
    ds_read_b64_tr_b16 v[212:213], v18 offset:192
    ds_read_b64_tr_b16 v[214:215], v18 offset:9408
    ds_read_b64_tr_b16 v[216:217], v18 offset:256
    ds_read_b64_tr_b16 v[218:219], v18 offset:9472
    ds_read_b64_tr_b16 v[220:221], v18 offset:320
    ds_read_b64_tr_b16 v[222:223], v18 offset:9536
    ds_read_b64_tr_b16 v[224:225], v18 offset:384
    ds_read_b64_tr_b16 v[226:227], v18 offset:9600
    s_waitcnt lgkmcnt(12)
    v_mfma_f32_32x32x16_bf16 v[56:71], v[200:203], v[28:31], v[56:71]
    ds_read_b64_tr_b16 v[228:229], v18 offset:448
    ds_read_b64_tr_b16 v[230:231], v18 offset:9664
    s_waitcnt lgkmcnt(12)
    v_mfma_f32_32x32x16_bf16 v[72:87], v[204:207], v[28:31], v[72:87]
    ds_read_b64_tr_b16 v[200:201], v18 offset:512
    ds_read_b64_tr_b16 v[202:203], v18 offset:9728
    s_waitcnt lgkmcnt(12)
    v_mfma_f32_32x32x16_bf16 v[88:103], v[208:211], v[28:31], v[88:103]
    s_waitcnt lgkmcnt(10)
    v_mfma_f32_32x32x16_bf16 v[104:119], v[212:215], v[28:31], v[104:119]
    s_waitcnt lgkmcnt(8)
    v_mfma_f32_32x32x16_bf16 v[120:135], v[216:219], v[28:31], v[120:135]
    s_waitcnt lgkmcnt(6)
    v_mfma_f32_32x32x16_bf16 v[136:151], v[220:223], v[28:31], v[136:151]
    s_waitcnt lgkmcnt(4)
    v_mfma_f32_32x32x16_bf16 v[152:167], v[224:227], v[28:31], v[152:167]
    s_waitcnt lgkmcnt(2)
    v_mfma_f32_32x32x16_bf16 v[168:183], v[228:231], v[28:31], v[168:183]
    s_waitcnt lgkmcnt(0)
    v_mfma_f32_32x32x16_bf16 v[184:199], v[200:203], v[28:31], v[184:199]
    s_waitcnt vmcnt(10)
    s_barrier
    s_add_u32 m0, s31, 36864
    s_mov_b32 s35, 92160
    buffer_load_dwordx4 v236, s[20:23], s35 offen lds
    s_add_u32 m0, s31, 45056
    s_mov_b32 s35, 92160
    buffer_load_dwordx4 v237, s[20:23], s35 offen lds
    s_add_u32 m0, s31, 53248
    s_mov_b32 s35, 92160
    buffer_load_dwordx4 v238, s[20:23], s35 offen lds
    s_add_u32 m0, s31, 61440
    s_mov_b32 s35, 92160
    buffer_load_dwordx4 v239, s[20:23], s35 offen lds
    s_and_b32 s34, s31, 0xfff
    s_add_u32 m0, s34, 69632
    s_mov_b32 s35, 92160
    buffer_load_dwordx4 v240, s[20:23], s35 offen lds
    v_add_u32 v18, 73728, v241
    ds_read_b64_tr_b16 v[200:201], v18 offset:0
    ds_read_b64_tr_b16 v[202:203], v18 offset:9216
    ds_read_b64_tr_b16 v[204:205], v18 offset:64
    ds_read_b64_tr_b16 v[206:207], v18 offset:9280
    ds_read_b64_tr_b16 v[208:209], v18 offset:128
    ds_read_b64_tr_b16 v[210:211], v18 offset:9344
    ds_read_b64_tr_b16 v[212:213], v18 offset:192
    ds_read_b64_tr_b16 v[214:215], v18 offset:9408
    ds_read_b64_tr_b16 v[216:217], v18 offset:256
    ds_read_b64_tr_b16 v[218:219], v18 offset:9472
    ds_read_b64_tr_b16 v[220:221], v18 offset:320
    ds_read_b64_tr_b16 v[222:223], v18 offset:9536
    ds_read_b64_tr_b16 v[224:225], v18 offset:384
    ds_read_b64_tr_b16 v[226:227], v18 offset:9600
    s_waitcnt lgkmcnt(12)
    v_mfma_f32_32x32x16_bf16 v[56:71], v[200:203], v[32:35], v[56:71]
    ds_read_b64_tr_b16 v[228:229], v18 offset:448
    ds_read_b64_tr_b16 v[230:231], v18 offset:9664
    s_waitcnt lgkmcnt(12)
    v_mfma_f32_32x32x16_bf16 v[72:87], v[204:207], v[32:35], v[72:87]
    ds_read_b64_tr_b16 v[200:201], v18 offset:512
    ds_read_b64_tr_b16 v[202:203], v18 offset:9728
    s_waitcnt lgkmcnt(12)
    v_mfma_f32_32x32x16_bf16 v[88:103], v[208:211], v[32:35], v[88:103]
    s_waitcnt lgkmcnt(10)
    v_mfma_f32_32x32x16_bf16 v[104:119], v[212:215], v[32:35], v[104:119]
    s_waitcnt lgkmcnt(8)
    v_mfma_f32_32x32x16_bf16 v[120:135], v[216:219], v[32:35], v[120:135]
    s_waitcnt lgkmcnt(6)
    v_mfma_f32_32x32x16_bf16 v[136:151], v[220:223], v[32:35], v[136:151]
    s_waitcnt lgkmcnt(4)
    v_mfma_f32_32x32x16_bf16 v[152:167], v[224:227], v[32:35], v[152:167]
    s_waitcnt lgkmcnt(2)
    v_mfma_f32_32x32x16_bf16 v[168:183], v[228:231], v[32:35], v[168:183]
    s_waitcnt lgkmcnt(0)
    v_mfma_f32_32x32x16_bf16 v[184:199], v[200:203], v[32:35], v[184:199]
    s_waitcnt vmcnt(10)
    s_barrier
    s_add_u32 m0, s31, 73728
    s_mov_b32 s35, 110592
    buffer_load_dwordx4 v236, s[20:23], s35 offen lds
    s_add_u32 m0, s31, 81920
    s_mov_b32 s35, 110592
    buffer_load_dwordx4 v237, s[20:23], s35 offen lds
    s_add_u32 m0, s31, 90112
    s_mov_b32 s35, 110592
    buffer_load_dwordx4 v238, s[20:23], s35 offen lds
    s_add_u32 m0, s31, 98304
    s_mov_b32 s35, 110592
    buffer_load_dwordx4 v239, s[20:23], s35 offen lds
    s_and_b32 s34, s31, 0xfff
    s_add_u32 m0, s34, 106496
    s_mov_b32 s35, 110592
    buffer_load_dwordx4 v240, s[20:23], s35 offen lds
    v_add_u32 v18, 110592, v241
    ds_read_b64_tr_b16 v[200:201], v18 offset:0
    ds_read_b64_tr_b16 v[202:203], v18 offset:9216
    ds_read_b64_tr_b16 v[204:205], v18 offset:64
    ds_read_b64_tr_b16 v[206:207], v18 offset:9280
    ds_read_b64_tr_b16 v[208:209], v18 offset:128
    ds_read_b64_tr_b16 v[210:211], v18 offset:9344
    ds_read_b64_tr_b16 v[212:213], v18 offset:192
    ds_read_b64_tr_b16 v[214:215], v18 offset:9408
    ds_read_b64_tr_b16 v[216:217], v18 offset:256
    ds_read_b64_tr_b16 v[218:219], v18 offset:9472
    ds_read_b64_tr_b16 v[220:221], v18 offset:320
    ds_read_b64_tr_b16 v[222:223], v18 offset:9536
    ds_read_b64_tr_b16 v[224:225], v18 offset:384
    ds_read_b64_tr_b16 v[226:227], v18 offset:9600
    s_waitcnt lgkmcnt(12)
    v_mfma_f32_32x32x16_bf16 v[56:71], v[200:203], v[36:39], v[56:71]
    ds_read_b64_tr_b16 v[228:229], v18 offset:448
    ds_read_b64_tr_b16 v[230:231], v18 offset:9664
    s_waitcnt lgkmcnt(12)
    v_mfma_f32_32x32x16_bf16 v[72:87], v[204:207], v[36:39], v[72:87]
    ds_read_b64_tr_b16 v[200:201], v18 offset:512
    ds_read_b64_tr_b16 v[202:203], v18 offset:9728
    s_waitcnt lgkmcnt(12)
    v_mfma_f32_32x32x16_bf16 v[88:103], v[208:211], v[36:39], v[88:103]
    s_waitcnt lgkmcnt(10)
    v_mfma_f32_32x32x16_bf16 v[104:119], v[212:215], v[36:39], v[104:119]
    s_waitcnt lgkmcnt(8)
    v_mfma_f32_32x32x16_bf16 v[120:135], v[216:219], v[36:39], v[120:135]
    s_waitcnt lgkmcnt(6)
    v_mfma_f32_32x32x16_bf16 v[136:151], v[220:223], v[36:39], v[136:151]
    s_waitcnt lgkmcnt(4)
    v_mfma_f32_32x32x16_bf16 v[152:167], v[224:227], v[36:39], v[152:167]
    s_waitcnt lgkmcnt(2)
    v_mfma_f32_32x32x16_bf16 v[168:183], v[228:231], v[36:39], v[168:183]
    s_waitcnt lgkmcnt(0)
    v_mfma_f32_32x32x16_bf16 v[184:199], v[200:203], v[36:39], v[184:199]
    s_waitcnt vmcnt(10)
    s_barrier
    s_add_u32 m0, s31, 110592
    s_mov_b32 s35, 129024
    buffer_load_dwordx4 v236, s[20:23], s35 offen lds
    s_add_u32 m0, s31, 118784
    s_mov_b32 s35, 129024
    buffer_load_dwordx4 v237, s[20:23], s35 offen lds
    s_add_u32 m0, s31, 126976
    s_mov_b32 s35, 129024
    buffer_load_dwordx4 v238, s[20:23], s35 offen lds
    s_add_u32 m0, s31, 135168
    s_mov_b32 s35, 129024
    buffer_load_dwordx4 v239, s[20:23], s35 offen lds
    s_and_b32 s34, s31, 0xfff
    s_add_u32 m0, s34, 143360
    s_mov_b32 s35, 129024
    buffer_load_dwordx4 v240, s[20:23], s35 offen lds
    v_add_u32 v18, 0, v241
    ds_read_b64_tr_b16 v[200:201], v18 offset:0
    ds_read_b64_tr_b16 v[202:203], v18 offset:9216
    ds_read_b64_tr_b16 v[204:205], v18 offset:64
    ds_read_b64_tr_b16 v[206:207], v18 offset:9280
    ds_read_b64_tr_b16 v[208:209], v18 offset:128
    ds_read_b64_tr_b16 v[210:211], v18 offset:9344
    ds_read_b64_tr_b16 v[212:213], v18 offset:192
    ds_read_b64_tr_b16 v[214:215], v18 offset:9408
    ds_read_b64_tr_b16 v[216:217], v18 offset:256
    ds_read_b64_tr_b16 v[218:219], v18 offset:9472
    ds_read_b64_tr_b16 v[220:221], v18 offset:320
    ds_read_b64_tr_b16 v[222:223], v18 offset:9536
    ds_read_b64_tr_b16 v[224:225], v18 offset:384
    ds_read_b64_tr_b16 v[226:227], v18 offset:9600
    s_waitcnt lgkmcnt(12)
    v_mfma_f32_32x32x16_bf16 v[56:71], v[200:203], v[40:43], v[56:71]
    ds_read_b64_tr_b16 v[228:229], v18 offset:448
    ds_read_b64_tr_b16 v[230:231], v18 offset:9664
    s_waitcnt lgkmcnt(12)
    v_mfma_f32_32x32x16_bf16 v[72:87], v[204:207], v[40:43], v[72:87]
    ds_read_b64_tr_b16 v[200:201], v18 offset:512
    ds_read_b64_tr_b16 v[202:203], v18 offset:9728
    s_waitcnt lgkmcnt(12)
    v_mfma_f32_32x32x16_bf16 v[88:103], v[208:211], v[40:43], v[88:103]
    s_waitcnt lgkmcnt(10)
    v_mfma_f32_32x32x16_bf16 v[104:119], v[212:215], v[40:43], v[104:119]
    s_waitcnt lgkmcnt(8)
    v_mfma_f32_32x32x16_bf16 v[120:135], v[216:219], v[40:43], v[120:135]
    s_waitcnt lgkmcnt(6)
    v_mfma_f32_32x32x16_bf16 v[136:151], v[220:223], v[40:43], v[136:151]
    s_waitcnt lgkmcnt(4)
    v_mfma_f32_32x32x16_bf16 v[152:167], v[224:227], v[40:43], v[152:167]
    s_waitcnt lgkmcnt(2)
    v_mfma_f32_32x32x16_bf16 v[168:183], v[228:231], v[40:43], v[168:183]
    s_waitcnt lgkmcnt(0)
    v_mfma_f32_32x32x16_bf16 v[184:199], v[200:203], v[40:43], v[184:199]
    s_waitcnt vmcnt(10)
    s_barrier
    v_add_u32 v18, 36864, v241
    ds_read_b64_tr_b16 v[200:201], v18 offset:0
    ds_read_b64_tr_b16 v[202:203], v18 offset:9216
    ds_read_b64_tr_b16 v[204:205], v18 offset:64
    ds_read_b64_tr_b16 v[206:207], v18 offset:9280
    ds_read_b64_tr_b16 v[208:209], v18 offset:128
    ds_read_b64_tr_b16 v[210:211], v18 offset:9344
    ds_read_b64_tr_b16 v[212:213], v18 offset:192
    ds_read_b64_tr_b16 v[214:215], v18 offset:9408
    ds_read_b64_tr_b16 v[216:217], v18 offset:256
    ds_read_b64_tr_b16 v[218:219], v18 offset:9472
    ds_read_b64_tr_b16 v[220:221], v18 offset:320
    ds_read_b64_tr_b16 v[222:223], v18 offset:9536
    ds_read_b64_tr_b16 v[224:225], v18 offset:384
    ds_read_b64_tr_b16 v[226:227], v18 offset:9600
    s_waitcnt lgkmcnt(12)
    v_mfma_f32_32x32x16_bf16 v[56:71], v[200:203], v[44:47], v[56:71]
    ds_read_b64_tr_b16 v[228:229], v18 offset:448
    ds_read_b64_tr_b16 v[230:231], v18 offset:9664
    s_waitcnt lgkmcnt(12)
    v_mfma_f32_32x32x16_bf16 v[72:87], v[204:207], v[44:47], v[72:87]
    ds_read_b64_tr_b16 v[200:201], v18 offset:512
    ds_read_b64_tr_b16 v[202:203], v18 offset:9728
    s_waitcnt lgkmcnt(12)
    v_mfma_f32_32x32x16_bf16 v[88:103], v[208:211], v[44:47], v[88:103]
    s_waitcnt lgkmcnt(10)
    v_mfma_f32_32x32x16_bf16 v[104:119], v[212:215], v[44:47], v[104:119]
    s_waitcnt lgkmcnt(8)
    v_mfma_f32_32x32x16_bf16 v[120:135], v[216:219], v[44:47], v[120:135]
    s_waitcnt lgkmcnt(6)
    v_mfma_f32_32x32x16_bf16 v[136:151], v[220:223], v[44:47], v[136:151]
    s_waitcnt lgkmcnt(4)
    v_mfma_f32_32x32x16_bf16 v[152:167], v[224:227], v[44:47], v[152:167]
    s_waitcnt lgkmcnt(2)
    v_mfma_f32_32x32x16_bf16 v[168:183], v[228:231], v[44:47], v[168:183]
    s_waitcnt lgkmcnt(0)
    v_mfma_f32_32x32x16_bf16 v[184:199], v[200:203], v[44:47], v[184:199]
    s_waitcnt vmcnt(5)
    s_barrier
    v_add_u32 v18, 73728, v241
    ds_read_b64_tr_b16 v[200:201], v18 offset:0
    ds_read_b64_tr_b16 v[202:203], v18 offset:9216
    ds_read_b64_tr_b16 v[204:205], v18 offset:64
    ds_read_b64_tr_b16 v[206:207], v18 offset:9280
    ds_read_b64_tr_b16 v[208:209], v18 offset:128
    ds_read_b64_tr_b16 v[210:211], v18 offset:9344
    ds_read_b64_tr_b16 v[212:213], v18 offset:192
    ds_read_b64_tr_b16 v[214:215], v18 offset:9408
    ds_read_b64_tr_b16 v[216:217], v18 offset:256
    ds_read_b64_tr_b16 v[218:219], v18 offset:9472
    ds_read_b64_tr_b16 v[220:221], v18 offset:320
    ds_read_b64_tr_b16 v[222:223], v18 offset:9536
    ds_read_b64_tr_b16 v[224:225], v18 offset:384
    ds_read_b64_tr_b16 v[226:227], v18 offset:9600
    s_waitcnt lgkmcnt(12)
    v_mfma_f32_32x32x16_bf16 v[56:71], v[200:203], v[48:51], v[56:71]
    ds_read_b64_tr_b16 v[228:229], v18 offset:448
    ds_read_b64_tr_b16 v[230:231], v18 offset:9664
    s_waitcnt lgkmcnt(12)
    v_mfma_f32_32x32x16_bf16 v[72:87], v[204:207], v[48:51], v[72:87]
    ds_read_b64_tr_b16 v[200:201], v18 offset:512
    ds_read_b64_tr_b16 v[202:203], v18 offset:9728
    s_waitcnt lgkmcnt(12)
    v_mfma_f32_32x32x16_bf16 v[88:103], v[208:211], v[48:51], v[88:103]
    s_waitcnt lgkmcnt(10)
    v_mfma_f32_32x32x16_bf16 v[104:119], v[212:215], v[48:51], v[104:119]
    s_waitcnt lgkmcnt(8)
    v_mfma_f32_32x32x16_bf16 v[120:135], v[216:219], v[48:51], v[120:135]
    s_waitcnt lgkmcnt(6)
    v_mfma_f32_32x32x16_bf16 v[136:151], v[220:223], v[48:51], v[136:151]
    s_waitcnt lgkmcnt(4)
    v_mfma_f32_32x32x16_bf16 v[152:167], v[224:227], v[48:51], v[152:167]
    s_waitcnt lgkmcnt(2)
    v_mfma_f32_32x32x16_bf16 v[168:183], v[228:231], v[48:51], v[168:183]
    s_waitcnt lgkmcnt(0)
    v_mfma_f32_32x32x16_bf16 v[184:199], v[200:203], v[48:51], v[184:199]
    s_waitcnt vmcnt(0)
    s_barrier
    v_add_u32 v18, 110592, v241
    ds_read_b64_tr_b16 v[200:201], v18 offset:0
    ds_read_b64_tr_b16 v[202:203], v18 offset:9216
    ds_read_b64_tr_b16 v[204:205], v18 offset:64
    ds_read_b64_tr_b16 v[206:207], v18 offset:9280
    ds_read_b64_tr_b16 v[208:209], v18 offset:128
    ds_read_b64_tr_b16 v[210:211], v18 offset:9344
    ds_read_b64_tr_b16 v[212:213], v18 offset:192
    ds_read_b64_tr_b16 v[214:215], v18 offset:9408
    ds_read_b64_tr_b16 v[216:217], v18 offset:256
    ds_read_b64_tr_b16 v[218:219], v18 offset:9472
    ds_read_b64_tr_b16 v[220:221], v18 offset:320
    ds_read_b64_tr_b16 v[222:223], v18 offset:9536
    ds_read_b64_tr_b16 v[224:225], v18 offset:384
    ds_read_b64_tr_b16 v[226:227], v18 offset:9600
    s_waitcnt lgkmcnt(12)
    v_mfma_f32_32x32x16_bf16 v[56:71], v[200:203], v[52:55], v[56:71]
    ds_read_b64_tr_b16 v[228:229], v18 offset:448
    ds_read_b64_tr_b16 v[230:231], v18 offset:9664
    s_waitcnt lgkmcnt(12)
    v_mfma_f32_32x32x16_bf16 v[72:87], v[204:207], v[52:55], v[72:87]
    ds_read_b64_tr_b16 v[200:201], v18 offset:512
    ds_read_b64_tr_b16 v[202:203], v18 offset:9728
    s_waitcnt lgkmcnt(12)
    v_mfma_f32_32x32x16_bf16 v[88:103], v[208:211], v[52:55], v[88:103]
    s_waitcnt lgkmcnt(10)
    v_mfma_f32_32x32x16_bf16 v[104:119], v[212:215], v[52:55], v[104:119]
    s_waitcnt lgkmcnt(8)
    v_mfma_f32_32x32x16_bf16 v[120:135], v[216:219], v[52:55], v[120:135]
    s_waitcnt lgkmcnt(6)
    v_mfma_f32_32x32x16_bf16 v[136:151], v[220:223], v[52:55], v[136:151]
    s_waitcnt lgkmcnt(4)
    v_mfma_f32_32x32x16_bf16 v[152:167], v[224:227], v[52:55], v[152:167]
    s_waitcnt lgkmcnt(2)
    v_mfma_f32_32x32x16_bf16 v[168:183], v[228:231], v[52:55], v[168:183]
    s_waitcnt lgkmcnt(0)
    v_mfma_f32_32x32x16_bf16 v[184:199], v[200:203], v[52:55], v[184:199]
    s_nop 7
    s_nop 7
    s_barrier
    s_lshl_b32 s32, s40, 5
    v_add_u32 v244, s32, v246
    s_movk_i32 s33, 2320
    v_mul_lo_u32 v244, v244, s33
    v_lshl_add_u32 v244, v245, 4, v244
    s_mul_i32 s32, s29, 1152
    v_add_u32 v244, s32, v244
    s_cmp_eq_u32 s39, 0
    s_cbranch_scc1 L_head0
    ds_write_b128 v244, v[56:59] offset:0
    ds_write_b128 v244, v[60:63] offset:32
    ds_write_b128 v244, v[64:67] offset:64
    ds_write_b128 v244, v[68:71] offset:96
    ds_write_b128 v244, v[72:75] offset:128
    ds_write_b128 v244, v[76:79] offset:160
    ds_write_b128 v244, v[80:83] offset:192
    ds_write_b128 v244, v[84:87] offset:224
    ds_write_b128 v244, v[88:91] offset:256
    ds_write_b128 v244, v[92:95] offset:288
    ds_write_b128 v244, v[96:99] offset:320
    ds_write_b128 v244, v[100:103] offset:352
    ds_write_b128 v244, v[104:107] offset:384
    ds_write_b128 v244, v[108:111] offset:416
    ds_write_b128 v244, v[112:115] offset:448
    ds_write_b128 v244, v[116:119] offset:480
    ds_write_b128 v244, v[120:123] offset:512
    ds_write_b128 v244, v[124:127] offset:544
    ds_write_b128 v244, v[128:131] offset:576
    ds_write_b128 v244, v[132:135] offset:608
    ds_write_b128 v244, v[136:139] offset:640
    ds_write_b128 v244, v[140:143] offset:672
    ds_write_b128 v244, v[144:147] offset:704
    ds_write_b128 v244, v[148:151] offset:736
    ds_write_b128 v244, v[152:155] offset:768
    ds_write_b128 v244, v[156:159] offset:800
    ds_write_b128 v244, v[160:163] offset:832
    ds_write_b128 v244, v[164:167] offset:864
    ds_write_b128 v244, v[168:171] offset:896
    ds_write_b128 v244, v[172:175] offset:928
    ds_write_b128 v244, v[176:179] offset:960
    ds_write_b128 v244, v[180:183] offset:992
    ds_write_b128 v244, v[184:187] offset:1024
    ds_write_b128 v244, v[188:191] offset:1056
    ds_write_b128 v244, v[192:195] offset:1088
    ds_write_b128 v244, v[196:199] offset:1120
    s_waitcnt lgkmcnt(0)
    s_barrier
    s_branch L_headdone
L_head0:
    s_barrier
    ds_read_b128 v[200:203], v244 offset:0
    ds_read_b128 v[204:207], v244 offset:32
    ds_read_b128 v[208:211], v244 offset:64
    ds_read_b128 v[212:215], v244 offset:96
    ds_read_b128 v[216:219], v244 offset:128
    ds_read_b128 v[220:223], v244 offset:160
    s_waitcnt lgkmcnt(5)
    v_add_f32 v56, v56, v200
    v_add_f32 v57, v57, v201
    v_add_f32 v58, v58, v202
    v_add_f32 v59, v59, v203
    s_waitcnt lgkmcnt(4)
    v_add_f32 v60, v60, v204
    v_add_f32 v61, v61, v205
    v_add_f32 v62, v62, v206
    v_add_f32 v63, v63, v207
    s_waitcnt lgkmcnt(3)
    v_add_f32 v64, v64, v208
    v_add_f32 v65, v65, v209
    v_add_f32 v66, v66, v210
    v_add_f32 v67, v67, v211
    s_waitcnt lgkmcnt(2)
    v_add_f32 v68, v68, v212
    v_add_f32 v69, v69, v213
    v_add_f32 v70, v70, v214
    v_add_f32 v71, v71, v215
    s_waitcnt lgkmcnt(1)
    v_add_f32 v72, v72, v216
    v_add_f32 v73, v73, v217
    v_add_f32 v74, v74, v218
    v_add_f32 v75, v75, v219
    s_waitcnt lgkmcnt(0)
    v_add_f32 v76, v76, v220
    v_add_f32 v77, v77, v221
    v_add_f32 v78, v78, v222
    v_add_f32 v79, v79, v223
    v_cvt_pk_bf16_f32 v56, v56, v57
    v_cvt_pk_bf16_f32 v57, v58, v59
    ds_write_b64 v244, v[56:57] offset:0
    v_cvt_pk_bf16_f32 v60, v60, v61
    v_cvt_pk_bf16_f32 v61, v62, v63
    ds_write_b64 v244, v[60:61] offset:32
    v_cvt_pk_bf16_f32 v64, v64, v65
    v_cvt_pk_bf16_f32 v65, v66, v67
    ds_write_b64 v244, v[64:65] offset:64
    v_cvt_pk_bf16_f32 v68, v68, v69
    v_cvt_pk_bf16_f32 v69, v70, v71
    ds_write_b64 v244, v[68:69] offset:96
    v_cvt_pk_bf16_f32 v72, v72, v73
    v_cvt_pk_bf16_f32 v73, v74, v75
    ds_write_b64 v244, v[72:73] offset:128
    v_cvt_pk_bf16_f32 v76, v76, v77
    v_cvt_pk_bf16_f32 v77, v78, v79
    ds_write_b64 v244, v[76:77] offset:160
    ds_read_b128 v[200:203], v244 offset:192
    ds_read_b128 v[204:207], v244 offset:224
    ds_read_b128 v[208:211], v244 offset:256
    ds_read_b128 v[212:215], v244 offset:288
    ds_read_b128 v[216:219], v244 offset:320
    ds_read_b128 v[220:223], v244 offset:352
    s_waitcnt lgkmcnt(5)
    v_add_f32 v80, v80, v200
    v_add_f32 v81, v81, v201
    v_add_f32 v82, v82, v202
    v_add_f32 v83, v83, v203
    s_waitcnt lgkmcnt(4)
    v_add_f32 v84, v84, v204
    v_add_f32 v85, v85, v205
    v_add_f32 v86, v86, v206
    v_add_f32 v87, v87, v207
    s_waitcnt lgkmcnt(3)
    v_add_f32 v88, v88, v208
    v_add_f32 v89, v89, v209
    v_add_f32 v90, v90, v210
    v_add_f32 v91, v91, v211
    s_waitcnt lgkmcnt(2)
    v_add_f32 v92, v92, v212
    v_add_f32 v93, v93, v213
    v_add_f32 v94, v94, v214
    v_add_f32 v95, v95, v215
    s_waitcnt lgkmcnt(1)
    v_add_f32 v96, v96, v216
    v_add_f32 v97, v97, v217
    v_add_f32 v98, v98, v218
    v_add_f32 v99, v99, v219
    s_waitcnt lgkmcnt(0)
    v_add_f32 v100, v100, v220
    v_add_f32 v101, v101, v221
    v_add_f32 v102, v102, v222
    v_add_f32 v103, v103, v223
    v_cvt_pk_bf16_f32 v80, v80, v81
    v_cvt_pk_bf16_f32 v81, v82, v83
    ds_write_b64 v244, v[80:81] offset:192
    v_cvt_pk_bf16_f32 v84, v84, v85
    v_cvt_pk_bf16_f32 v85, v86, v87
    ds_write_b64 v244, v[84:85] offset:224
    v_cvt_pk_bf16_f32 v88, v88, v89
    v_cvt_pk_bf16_f32 v89, v90, v91
    ds_write_b64 v244, v[88:89] offset:256
    v_cvt_pk_bf16_f32 v92, v92, v93
    v_cvt_pk_bf16_f32 v93, v94, v95
    ds_write_b64 v244, v[92:93] offset:288
    v_cvt_pk_bf16_f32 v96, v96, v97
    v_cvt_pk_bf16_f32 v97, v98, v99
    ds_write_b64 v244, v[96:97] offset:320
    v_cvt_pk_bf16_f32 v100, v100, v101
    v_cvt_pk_bf16_f32 v101, v102, v103
    ds_write_b64 v244, v[100:101] offset:352
    ds_read_b128 v[200:203], v244 offset:384
    ds_read_b128 v[204:207], v244 offset:416
    ds_read_b128 v[208:211], v244 offset:448
    ds_read_b128 v[212:215], v244 offset:480
    ds_read_b128 v[216:219], v244 offset:512
    ds_read_b128 v[220:223], v244 offset:544
    s_waitcnt lgkmcnt(5)
    v_add_f32 v104, v104, v200
    v_add_f32 v105, v105, v201
    v_add_f32 v106, v106, v202
    v_add_f32 v107, v107, v203
    s_waitcnt lgkmcnt(4)
    v_add_f32 v108, v108, v204
    v_add_f32 v109, v109, v205
    v_add_f32 v110, v110, v206
    v_add_f32 v111, v111, v207
    s_waitcnt lgkmcnt(3)
    v_add_f32 v112, v112, v208
    v_add_f32 v113, v113, v209
    v_add_f32 v114, v114, v210
    v_add_f32 v115, v115, v211
    s_waitcnt lgkmcnt(2)
    v_add_f32 v116, v116, v212
    v_add_f32 v117, v117, v213
    v_add_f32 v118, v118, v214
    v_add_f32 v119, v119, v215
    s_waitcnt lgkmcnt(1)
    v_add_f32 v120, v120, v216
    v_add_f32 v121, v121, v217
    v_add_f32 v122, v122, v218
    v_add_f32 v123, v123, v219
    s_waitcnt lgkmcnt(0)
    v_add_f32 v124, v124, v220
    v_add_f32 v125, v125, v221
    v_add_f32 v126, v126, v222
    v_add_f32 v127, v127, v223
    v_cvt_pk_bf16_f32 v104, v104, v105
    v_cvt_pk_bf16_f32 v105, v106, v107
    ds_write_b64 v244, v[104:105] offset:384
    v_cvt_pk_bf16_f32 v108, v108, v109
    v_cvt_pk_bf16_f32 v109, v110, v111
    ds_write_b64 v244, v[108:109] offset:416
    v_cvt_pk_bf16_f32 v112, v112, v113
    v_cvt_pk_bf16_f32 v113, v114, v115
    ds_write_b64 v244, v[112:113] offset:448
    v_cvt_pk_bf16_f32 v116, v116, v117
    v_cvt_pk_bf16_f32 v117, v118, v119
    ds_write_b64 v244, v[116:117] offset:480
    v_cvt_pk_bf16_f32 v120, v120, v121
    v_cvt_pk_bf16_f32 v121, v122, v123
    ds_write_b64 v244, v[120:121] offset:512
    v_cvt_pk_bf16_f32 v124, v124, v125
    v_cvt_pk_bf16_f32 v125, v126, v127
    ds_write_b64 v244, v[124:125] offset:544
    ds_read_b128 v[200:203], v244 offset:576
    ds_read_b128 v[204:207], v244 offset:608
    ds_read_b128 v[208:211], v244 offset:640
    ds_read_b128 v[212:215], v244 offset:672
    ds_read_b128 v[216:219], v244 offset:704
    ds_read_b128 v[220:223], v244 offset:736
    s_waitcnt lgkmcnt(5)
    v_add_f32 v128, v128, v200
    v_add_f32 v129, v129, v201
    v_add_f32 v130, v130, v202
    v_add_f32 v131, v131, v203
    s_waitcnt lgkmcnt(4)
    v_add_f32 v132, v132, v204
    v_add_f32 v133, v133, v205
    v_add_f32 v134, v134, v206
    v_add_f32 v135, v135, v207
    s_waitcnt lgkmcnt(3)
    v_add_f32 v136, v136, v208
    v_add_f32 v137, v137, v209
    v_add_f32 v138, v138, v210
    v_add_f32 v139, v139, v211
    s_waitcnt lgkmcnt(2)
    v_add_f32 v140, v140, v212
    v_add_f32 v141, v141, v213
    v_add_f32 v142, v142, v214
    v_add_f32 v143, v143, v215
    s_waitcnt lgkmcnt(1)
    v_add_f32 v144, v144, v216
    v_add_f32 v145, v145, v217
    v_add_f32 v146, v146, v218
    v_add_f32 v147, v147, v219
    s_waitcnt lgkmcnt(0)
    v_add_f32 v148, v148, v220
    v_add_f32 v149, v149, v221
    v_add_f32 v150, v150, v222
    v_add_f32 v151, v151, v223
    v_cvt_pk_bf16_f32 v128, v128, v129
    v_cvt_pk_bf16_f32 v129, v130, v131
    ds_write_b64 v244, v[128:129] offset:576
    v_cvt_pk_bf16_f32 v132, v132, v133
    v_cvt_pk_bf16_f32 v133, v134, v135
    ds_write_b64 v244, v[132:133] offset:608
    v_cvt_pk_bf16_f32 v136, v136, v137
    v_cvt_pk_bf16_f32 v137, v138, v139
    ds_write_b64 v244, v[136:137] offset:640
    v_cvt_pk_bf16_f32 v140, v140, v141
    v_cvt_pk_bf16_f32 v141, v142, v143
    ds_write_b64 v244, v[140:141] offset:672
    v_cvt_pk_bf16_f32 v144, v144, v145
    v_cvt_pk_bf16_f32 v145, v146, v147
    ds_write_b64 v244, v[144:145] offset:704
    v_cvt_pk_bf16_f32 v148, v148, v149
    v_cvt_pk_bf16_f32 v149, v150, v151
    ds_write_b64 v244, v[148:149] offset:736
    ds_read_b128 v[200:203], v244 offset:768
    ds_read_b128 v[204:207], v244 offset:800
    ds_read_b128 v[208:211], v244 offset:832
    ds_read_b128 v[212:215], v244 offset:864
    ds_read_b128 v[216:219], v244 offset:896
    ds_read_b128 v[220:223], v244 offset:928
    s_waitcnt lgkmcnt(5)
    v_add_f32 v152, v152, v200
    v_add_f32 v153, v153, v201
    v_add_f32 v154, v154, v202
    v_add_f32 v155, v155, v203
    s_waitcnt lgkmcnt(4)
    v_add_f32 v156, v156, v204
    v_add_f32 v157, v157, v205
    v_add_f32 v158, v158, v206
    v_add_f32 v159, v159, v207
    s_waitcnt lgkmcnt(3)
    v_add_f32 v160, v160, v208
    v_add_f32 v161, v161, v209
    v_add_f32 v162, v162, v210
    v_add_f32 v163, v163, v211
    s_waitcnt lgkmcnt(2)
    v_add_f32 v164, v164, v212
    v_add_f32 v165, v165, v213
    v_add_f32 v166, v166, v214
    v_add_f32 v167, v167, v215
    s_waitcnt lgkmcnt(1)
    v_add_f32 v168, v168, v216
    v_add_f32 v169, v169, v217
    v_add_f32 v170, v170, v218
    v_add_f32 v171, v171, v219
    s_waitcnt lgkmcnt(0)
    v_add_f32 v172, v172, v220
    v_add_f32 v173, v173, v221
    v_add_f32 v174, v174, v222
    v_add_f32 v175, v175, v223
    v_cvt_pk_bf16_f32 v152, v152, v153
    v_cvt_pk_bf16_f32 v153, v154, v155
    ds_write_b64 v244, v[152:153] offset:768
    v_cvt_pk_bf16_f32 v156, v156, v157
    v_cvt_pk_bf16_f32 v157, v158, v159
    ds_write_b64 v244, v[156:157] offset:800
    v_cvt_pk_bf16_f32 v160, v160, v161
    v_cvt_pk_bf16_f32 v161, v162, v163
    ds_write_b64 v244, v[160:161] offset:832
    v_cvt_pk_bf16_f32 v164, v164, v165
    v_cvt_pk_bf16_f32 v165, v166, v167
    ds_write_b64 v244, v[164:165] offset:864
    v_cvt_pk_bf16_f32 v168, v168, v169
    v_cvt_pk_bf16_f32 v169, v170, v171
    ds_write_b64 v244, v[168:169] offset:896
    v_cvt_pk_bf16_f32 v172, v172, v173
    v_cvt_pk_bf16_f32 v173, v174, v175
    ds_write_b64 v244, v[172:173] offset:928
    ds_read_b128 v[200:203], v244 offset:960
    ds_read_b128 v[204:207], v244 offset:992
    ds_read_b128 v[208:211], v244 offset:1024
    ds_read_b128 v[212:215], v244 offset:1056
    ds_read_b128 v[216:219], v244 offset:1088
    ds_read_b128 v[220:223], v244 offset:1120
    s_waitcnt lgkmcnt(5)
    v_add_f32 v176, v176, v200
    v_add_f32 v177, v177, v201
    v_add_f32 v178, v178, v202
    v_add_f32 v179, v179, v203
    s_waitcnt lgkmcnt(4)
    v_add_f32 v180, v180, v204
    v_add_f32 v181, v181, v205
    v_add_f32 v182, v182, v206
    v_add_f32 v183, v183, v207
    s_waitcnt lgkmcnt(3)
    v_add_f32 v184, v184, v208
    v_add_f32 v185, v185, v209
    v_add_f32 v186, v186, v210
    v_add_f32 v187, v187, v211
    s_waitcnt lgkmcnt(2)
    v_add_f32 v188, v188, v212
    v_add_f32 v189, v189, v213
    v_add_f32 v190, v190, v214
    v_add_f32 v191, v191, v215
    s_waitcnt lgkmcnt(1)
    v_add_f32 v192, v192, v216
    v_add_f32 v193, v193, v217
    v_add_f32 v194, v194, v218
    v_add_f32 v195, v195, v219
    s_waitcnt lgkmcnt(0)
    v_add_f32 v196, v196, v220
    v_add_f32 v197, v197, v221
    v_add_f32 v198, v198, v222
    v_add_f32 v199, v199, v223
    v_cvt_pk_bf16_f32 v176, v176, v177
    v_cvt_pk_bf16_f32 v177, v178, v179
    ds_write_b64 v244, v[176:177] offset:960
    v_cvt_pk_bf16_f32 v180, v180, v181
    v_cvt_pk_bf16_f32 v181, v182, v183
    ds_write_b64 v244, v[180:181] offset:992
    v_cvt_pk_bf16_f32 v184, v184, v185
    v_cvt_pk_bf16_f32 v185, v186, v187
    ds_write_b64 v244, v[184:185] offset:1024
    v_cvt_pk_bf16_f32 v188, v188, v189
    v_cvt_pk_bf16_f32 v189, v190, v191
    ds_write_b64 v244, v[188:189] offset:1056
    v_cvt_pk_bf16_f32 v192, v192, v193
    v_cvt_pk_bf16_f32 v193, v194, v195
    ds_write_b64 v244, v[192:193] offset:1088
    v_cvt_pk_bf16_f32 v196, v196, v197
    v_cvt_pk_bf16_f32 v197, v198, v199
    ds_write_b64 v244, v[196:197] offset:1120
    s_waitcnt lgkmcnt(0)
L_headdone:
    s_barrier
    s_mul_i32 s32, s28, 18560
    v_lshl_add_u32 v18, v1, 5, s32
    s_mul_i32 s33, s28, 9216
    v_add_u32 v19, 0, v18
    ds_read2_b64 v[56:59], v19 offset0:0 offset1:2
    v_add_u32 v19, 2320, v18
    ds_read2_b64 v[60:63], v19 offset0:0 offset1:2
    v_add_u32 v19, 4640, v18
    ds_read2_b64 v[64:67], v19 offset0:0 offset1:2
    v_add_u32 v19, 6960, v18
    ds_read2_b64 v[68:71], v19 offset0:0 offset1:2
    v_add_u32 v19, 9280, v18
    ds_read2_b64 v[72:75], v19 offset0:0 offset1:2
    v_add_u32 v19, 11600, v18
    ds_read2_b64 v[76:79], v19 offset0:0 offset1:2
    v_add_u32 v19, 13920, v18
    ds_read2_b64 v[80:83], v19 offset0:0 offset1:2
    v_add_u32 v19, 16240, v18
    ds_read2_b64 v[84:87], v19 offset0:0 offset1:2
    v_lshrrev_b32 v20, 3, v1
    v_and_b32 v21, 7, v1
    s_movk_i32 s34, 2320
    v_mul_lo_u32 v22, v20, s34
    v_lshl_add_u32 v22, v21, 5, v22
    v_add_u32 v22, s32, v22
    v_add_u32 v22, 2048, v22
    ds_read2_b64 v[120:123], v22 offset0:0 offset1:2
    s_movk_i32 s34, 1152
    v_mul_lo_u32 v23, v20, s34
    v_lshl_add_u32 v23, v21, 4, v23
    s_waitcnt lgkmcnt(8)
    s_add_u32 s34, s33, 0
    buffer_store_dwordx4 v[56:59], v243, s[24:27], s34 offen sc1
    s_waitcnt lgkmcnt(7)
    s_add_u32 s34, s33, 1152
    buffer_store_dwordx4 v[60:63], v243, s[24:27], s34 offen sc1
    s_waitcnt lgkmcnt(6)
    s_add_u32 s34, s33, 2304
    buffer_store_dwordx4 v[64:67], v243, s[24:27], s34 offen sc1
    s_waitcnt lgkmcnt(5)
    s_add_u32 s34, s33, 3456
    buffer_store_dwordx4 v[68:71], v243, s[24:27], s34 offen sc1
    s_waitcnt lgkmcnt(4)
    s_add_u32 s34, s33, 4608
    buffer_store_dwordx4 v[72:75], v243, s[24:27], s34 offen sc1
    s_waitcnt lgkmcnt(3)
    s_add_u32 s34, s33, 5760
    buffer_store_dwordx4 v[76:79], v243, s[24:27], s34 offen sc1
    s_waitcnt lgkmcnt(2)
    s_add_u32 s34, s33, 6912
    buffer_store_dwordx4 v[80:83], v243, s[24:27], s34 offen sc1
    s_waitcnt lgkmcnt(1)
    s_add_u32 s34, s33, 8064
    buffer_store_dwordx4 v[84:87], v243, s[24:27], s34 offen sc1
    s_waitcnt lgkmcnt(0)
    buffer_store_dwordx4 v[120:123], v23, s[24:27], s33 offen offset:1024 sc1
    s_waitcnt vmcnt(0)
L_attn_done:
    s_endpgm
.globl red_kernel
.p2align 8
.type red_kernel,@function
red_kernel:
    s_cmp_ge_u32 s2, 288
    s_cbranch_scc1 L_red_done
    s_load_dwordx2 s[4:5], s[0:1], 56
    s_load_dwordx2 s[6:7], s[0:1], 40
    s_mov_b32 s8, 0xe38e38f
    s_mul_hi_u32 s9, s2, s8
    s_mul_i32 s10, s9, 18
    s_sub_u32 s10, s2, s10
    s_lshl_b32 s10, s10, 8
    v_add_u32 v1, s10, v0
    v_lshlrev_b32 v3, 4, v1
    s_waitcnt lgkmcnt(0)
    s_mul_i32 s11, s9, 1179648
    s_add_u32 s4, s4, s11
    s_addc_u32 s5, s5, 0
    s_mov_b32 s12, s4
    s_and_b32 s13, s5, 0xffff
    s_mov_b32 s14, 1179648
    s_mov_b32 s15, 0x00020000
    s_mul_i32 s11, s9, 73728
    s_add_u32 s6, s6, s11
    s_addc_u32 s7, s7, 0
    s_mov_b32 s16, s6
    s_and_b32 s17, s7, 0xffff
    s_mov_b32 s18, 73728
    s_mov_b32 s19, 0x00020000
    s_mov_b32 s20, 0
    buffer_load_dwordx4 v[16:19], v3, s[12:15], s20 offen
    s_mov_b32 s20, 73728
    buffer_load_dwordx4 v[20:23], v3, s[12:15], s20 offen
    s_mov_b32 s20, 147456
    buffer_load_dwordx4 v[24:27], v3, s[12:15], s20 offen
    s_mov_b32 s20, 221184
    buffer_load_dwordx4 v[28:31], v3, s[12:15], s20 offen
    s_mov_b32 s20, 294912
    buffer_load_dwordx4 v[32:35], v3, s[12:15], s20 offen
    s_mov_b32 s20, 368640
    buffer_load_dwordx4 v[36:39], v3, s[12:15], s20 offen
    s_mov_b32 s20, 442368
    buffer_load_dwordx4 v[40:43], v3, s[12:15], s20 offen
    s_mov_b32 s20, 516096
    buffer_load_dwordx4 v[44:47], v3, s[12:15], s20 offen
    s_mov_b32 s20, 589824
    buffer_load_dwordx4 v[48:51], v3, s[12:15], s20 offen
    s_mov_b32 s20, 663552
    buffer_load_dwordx4 v[52:55], v3, s[12:15], s20 offen
    s_mov_b32 s20, 737280
    buffer_load_dwordx4 v[56:59], v3, s[12:15], s20 offen
    s_mov_b32 s20, 811008
    buffer_load_dwordx4 v[60:63], v3, s[12:15], s20 offen
    s_mov_b32 s20, 884736
    buffer_load_dwordx4 v[64:67], v3, s[12:15], s20 offen
    s_mov_b32 s20, 958464
    buffer_load_dwordx4 v[68:71], v3, s[12:15], s20 offen
    s_mov_b32 s20, 1032192
    buffer_load_dwordx4 v[72:75], v3, s[12:15], s20 offen
    s_mov_b32 s20, 1105920
    buffer_load_dwordx4 v[76:79], v3, s[12:15], s20 offen
    v_mov_b32 v8, 0
    v_mov_b32 v9, 0
    v_mov_b32 v10, 0
    v_mov_b32 v11, 0
    v_mov_b32 v12, 0
    v_mov_b32 v13, 0
    v_mov_b32 v14, 0
    v_mov_b32 v15, 0
    s_waitcnt vmcnt(15)
    v_lshlrev_b32 v2, 16, v16
    v_and_b32 v16, 0xffff0000, v16
    v_add_f32 v8, v8, v2
    v_add_f32 v9, v9, v16
    v_lshlrev_b32 v2, 16, v17
    v_and_b32 v17, 0xffff0000, v17
    v_add_f32 v10, v10, v2
    v_add_f32 v11, v11, v17
    v_lshlrev_b32 v2, 16, v18
    v_and_b32 v18, 0xffff0000, v18
    v_add_f32 v12, v12, v2
    v_add_f32 v13, v13, v18
    v_lshlrev_b32 v2, 16, v19
    v_and_b32 v19, 0xffff0000, v19
    v_add_f32 v14, v14, v2
    v_add_f32 v15, v15, v19
    s_waitcnt vmcnt(14)
    v_lshlrev_b32 v2, 16, v20
    v_and_b32 v20, 0xffff0000, v20
    v_add_f32 v8, v8, v2
    v_add_f32 v9, v9, v20
    v_lshlrev_b32 v2, 16, v21
    v_and_b32 v21, 0xffff0000, v21
    v_add_f32 v10, v10, v2
    v_add_f32 v11, v11, v21
    v_lshlrev_b32 v2, 16, v22
    v_and_b32 v22, 0xffff0000, v22
    v_add_f32 v12, v12, v2
    v_add_f32 v13, v13, v22
    v_lshlrev_b32 v2, 16, v23
    v_and_b32 v23, 0xffff0000, v23
    v_add_f32 v14, v14, v2
    v_add_f32 v15, v15, v23
    s_waitcnt vmcnt(13)
    v_lshlrev_b32 v2, 16, v24
    v_and_b32 v24, 0xffff0000, v24
    v_add_f32 v8, v8, v2
    v_add_f32 v9, v9, v24
    v_lshlrev_b32 v2, 16, v25
    v_and_b32 v25, 0xffff0000, v25
    v_add_f32 v10, v10, v2
    v_add_f32 v11, v11, v25
    v_lshlrev_b32 v2, 16, v26
    v_and_b32 v26, 0xffff0000, v26
    v_add_f32 v12, v12, v2
    v_add_f32 v13, v13, v26
    v_lshlrev_b32 v2, 16, v27
    v_and_b32 v27, 0xffff0000, v27
    v_add_f32 v14, v14, v2
    v_add_f32 v15, v15, v27
    s_waitcnt vmcnt(12)
    v_lshlrev_b32 v2, 16, v28
    v_and_b32 v28, 0xffff0000, v28
    v_add_f32 v8, v8, v2
    v_add_f32 v9, v9, v28
    v_lshlrev_b32 v2, 16, v29
    v_and_b32 v29, 0xffff0000, v29
    v_add_f32 v10, v10, v2
    v_add_f32 v11, v11, v29
    v_lshlrev_b32 v2, 16, v30
    v_and_b32 v30, 0xffff0000, v30
    v_add_f32 v12, v12, v2
    v_add_f32 v13, v13, v30
    v_lshlrev_b32 v2, 16, v31
    v_and_b32 v31, 0xffff0000, v31
    v_add_f32 v14, v14, v2
    v_add_f32 v15, v15, v31
    s_waitcnt vmcnt(11)
    v_lshlrev_b32 v2, 16, v32
    v_and_b32 v32, 0xffff0000, v32
    v_add_f32 v8, v8, v2
    v_add_f32 v9, v9, v32
    v_lshlrev_b32 v2, 16, v33
    v_and_b32 v33, 0xffff0000, v33
    v_add_f32 v10, v10, v2
    v_add_f32 v11, v11, v33
    v_lshlrev_b32 v2, 16, v34
    v_and_b32 v34, 0xffff0000, v34
    v_add_f32 v12, v12, v2
    v_add_f32 v13, v13, v34
    v_lshlrev_b32 v2, 16, v35
    v_and_b32 v35, 0xffff0000, v35
    v_add_f32 v14, v14, v2
    v_add_f32 v15, v15, v35
    s_waitcnt vmcnt(10)
    v_lshlrev_b32 v2, 16, v36
    v_and_b32 v36, 0xffff0000, v36
    v_add_f32 v8, v8, v2
    v_add_f32 v9, v9, v36
    v_lshlrev_b32 v2, 16, v37
    v_and_b32 v37, 0xffff0000, v37
    v_add_f32 v10, v10, v2
    v_add_f32 v11, v11, v37
    v_lshlrev_b32 v2, 16, v38
    v_and_b32 v38, 0xffff0000, v38
    v_add_f32 v12, v12, v2
    v_add_f32 v13, v13, v38
    v_lshlrev_b32 v2, 16, v39
    v_and_b32 v39, 0xffff0000, v39
    v_add_f32 v14, v14, v2
    v_add_f32 v15, v15, v39
    s_waitcnt vmcnt(9)
    v_lshlrev_b32 v2, 16, v40
    v_and_b32 v40, 0xffff0000, v40
    v_add_f32 v8, v8, v2
    v_add_f32 v9, v9, v40
    v_lshlrev_b32 v2, 16, v41
    v_and_b32 v41, 0xffff0000, v41
    v_add_f32 v10, v10, v2
    v_add_f32 v11, v11, v41
    v_lshlrev_b32 v2, 16, v42
    v_and_b32 v42, 0xffff0000, v42
    v_add_f32 v12, v12, v2
    v_add_f32 v13, v13, v42
    v_lshlrev_b32 v2, 16, v43
    v_and_b32 v43, 0xffff0000, v43
    v_add_f32 v14, v14, v2
    v_add_f32 v15, v15, v43
    s_waitcnt vmcnt(8)
    v_lshlrev_b32 v2, 16, v44
    v_and_b32 v44, 0xffff0000, v44
    v_add_f32 v8, v8, v2
    v_add_f32 v9, v9, v44
    v_lshlrev_b32 v2, 16, v45
    v_and_b32 v45, 0xffff0000, v45
    v_add_f32 v10, v10, v2
    v_add_f32 v11, v11, v45
    v_lshlrev_b32 v2, 16, v46
    v_and_b32 v46, 0xffff0000, v46
    v_add_f32 v12, v12, v2
    v_add_f32 v13, v13, v46
    v_lshlrev_b32 v2, 16, v47
    v_and_b32 v47, 0xffff0000, v47
    v_add_f32 v14, v14, v2
    v_add_f32 v15, v15, v47
    s_waitcnt vmcnt(7)
    v_lshlrev_b32 v2, 16, v48
    v_and_b32 v48, 0xffff0000, v48
    v_add_f32 v8, v8, v2
    v_add_f32 v9, v9, v48
    v_lshlrev_b32 v2, 16, v49
    v_and_b32 v49, 0xffff0000, v49
    v_add_f32 v10, v10, v2
    v_add_f32 v11, v11, v49
    v_lshlrev_b32 v2, 16, v50
    v_and_b32 v50, 0xffff0000, v50
    v_add_f32 v12, v12, v2
    v_add_f32 v13, v13, v50
    v_lshlrev_b32 v2, 16, v51
    v_and_b32 v51, 0xffff0000, v51
    v_add_f32 v14, v14, v2
    v_add_f32 v15, v15, v51
    s_waitcnt vmcnt(6)
    v_lshlrev_b32 v2, 16, v52
    v_and_b32 v52, 0xffff0000, v52
    v_add_f32 v8, v8, v2
    v_add_f32 v9, v9, v52
    v_lshlrev_b32 v2, 16, v53
    v_and_b32 v53, 0xffff0000, v53
    v_add_f32 v10, v10, v2
    v_add_f32 v11, v11, v53
    v_lshlrev_b32 v2, 16, v54
    v_and_b32 v54, 0xffff0000, v54
    v_add_f32 v12, v12, v2
    v_add_f32 v13, v13, v54
    v_lshlrev_b32 v2, 16, v55
    v_and_b32 v55, 0xffff0000, v55
    v_add_f32 v14, v14, v2
    v_add_f32 v15, v15, v55
    s_waitcnt vmcnt(5)
    v_lshlrev_b32 v2, 16, v56
    v_and_b32 v56, 0xffff0000, v56
    v_add_f32 v8, v8, v2
    v_add_f32 v9, v9, v56
    v_lshlrev_b32 v2, 16, v57
    v_and_b32 v57, 0xffff0000, v57
    v_add_f32 v10, v10, v2
    v_add_f32 v11, v11, v57
    v_lshlrev_b32 v2, 16, v58
    v_and_b32 v58, 0xffff0000, v58
    v_add_f32 v12, v12, v2
    v_add_f32 v13, v13, v58
    v_lshlrev_b32 v2, 16, v59
    v_and_b32 v59, 0xffff0000, v59
    v_add_f32 v14, v14, v2
    v_add_f32 v15, v15, v59
    s_waitcnt vmcnt(4)
    v_lshlrev_b32 v2, 16, v60
    v_and_b32 v60, 0xffff0000, v60
    v_add_f32 v8, v8, v2
    v_add_f32 v9, v9, v60
    v_lshlrev_b32 v2, 16, v61
    v_and_b32 v61, 0xffff0000, v61
    v_add_f32 v10, v10, v2
    v_add_f32 v11, v11, v61
    v_lshlrev_b32 v2, 16, v62
    v_and_b32 v62, 0xffff0000, v62
    v_add_f32 v12, v12, v2
    v_add_f32 v13, v13, v62
    v_lshlrev_b32 v2, 16, v63
    v_and_b32 v63, 0xffff0000, v63
    v_add_f32 v14, v14, v2
    v_add_f32 v15, v15, v63
    s_waitcnt vmcnt(3)
    v_lshlrev_b32 v2, 16, v64
    v_and_b32 v64, 0xffff0000, v64
    v_add_f32 v8, v8, v2
    v_add_f32 v9, v9, v64
    v_lshlrev_b32 v2, 16, v65
    v_and_b32 v65, 0xffff0000, v65
    v_add_f32 v10, v10, v2
    v_add_f32 v11, v11, v65
    v_lshlrev_b32 v2, 16, v66
    v_and_b32 v66, 0xffff0000, v66
    v_add_f32 v12, v12, v2
    v_add_f32 v13, v13, v66
    v_lshlrev_b32 v2, 16, v67
    v_and_b32 v67, 0xffff0000, v67
    v_add_f32 v14, v14, v2
    v_add_f32 v15, v15, v67
    s_waitcnt vmcnt(2)
    v_lshlrev_b32 v2, 16, v68
    v_and_b32 v68, 0xffff0000, v68
    v_add_f32 v8, v8, v2
    v_add_f32 v9, v9, v68
    v_lshlrev_b32 v2, 16, v69
    v_and_b32 v69, 0xffff0000, v69
    v_add_f32 v10, v10, v2
    v_add_f32 v11, v11, v69
    v_lshlrev_b32 v2, 16, v70
    v_and_b32 v70, 0xffff0000, v70
    v_add_f32 v12, v12, v2
    v_add_f32 v13, v13, v70
    v_lshlrev_b32 v2, 16, v71
    v_and_b32 v71, 0xffff0000, v71
    v_add_f32 v14, v14, v2
    v_add_f32 v15, v15, v71
    s_waitcnt vmcnt(1)
    v_lshlrev_b32 v2, 16, v72
    v_and_b32 v72, 0xffff0000, v72
    v_add_f32 v8, v8, v2
    v_add_f32 v9, v9, v72
    v_lshlrev_b32 v2, 16, v73
    v_and_b32 v73, 0xffff0000, v73
    v_add_f32 v10, v10, v2
    v_add_f32 v11, v11, v73
    v_lshlrev_b32 v2, 16, v74
    v_and_b32 v74, 0xffff0000, v74
    v_add_f32 v12, v12, v2
    v_add_f32 v13, v13, v74
    v_lshlrev_b32 v2, 16, v75
    v_and_b32 v75, 0xffff0000, v75
    v_add_f32 v14, v14, v2
    v_add_f32 v15, v15, v75
    s_waitcnt vmcnt(0)
    v_lshlrev_b32 v2, 16, v76
    v_and_b32 v76, 0xffff0000, v76
    v_add_f32 v8, v8, v2
    v_add_f32 v9, v9, v76
    v_lshlrev_b32 v2, 16, v77
    v_and_b32 v77, 0xffff0000, v77
    v_add_f32 v10, v10, v2
    v_add_f32 v11, v11, v77
    v_lshlrev_b32 v2, 16, v78
    v_and_b32 v78, 0xffff0000, v78
    v_add_f32 v12, v12, v2
    v_add_f32 v13, v13, v78
    v_lshlrev_b32 v2, 16, v79
    v_and_b32 v79, 0xffff0000, v79
    v_add_f32 v14, v14, v2
    v_add_f32 v15, v15, v79
    v_cvt_pk_bf16_f32 v4, v8, v9
    v_cvt_pk_bf16_f32 v5, v10, v11
    v_cvt_pk_bf16_f32 v6, v12, v13
    v_cvt_pk_bf16_f32 v7, v14, v15
    buffer_store_dwordx4 v[4:7], v3, s[16:19], 0 offen
L_red_done:
    s_endpgm
.section .rodata,"a"
.p2align 6
.amdhsa_kernel attn_kernel
  .amdhsa_next_free_vgpr 256
  .amdhsa_next_free_sgpr 100
  .amdhsa_accum_offset 256
  .amdhsa_group_segment_fixed_size 0
  .amdhsa_kernarg_size 64
  .amdhsa_user_sgpr_count 2
  .amdhsa_user_sgpr_kernarg_segment_ptr 1
  .amdhsa_system_sgpr_workgroup_id_x 1
.end_amdhsa_kernel
.p2align 6
.amdhsa_kernel red_kernel
  .amdhsa_next_free_vgpr 80
  .amdhsa_next_free_sgpr 100
  .amdhsa_accum_offset 80
  .amdhsa_group_segment_fixed_size 0
  .amdhsa_kernarg_size 64
  .amdhsa_user_sgpr_count 2
  .amdhsa_user_sgpr_kernarg_segment_ptr 1
  .amdhsa_system_sgpr_workgroup_id_x 1
.end_amdhsa_kernel
```
